```python
import torch

def _softmax(x, axis=-1):
    return torch.softmax(x, dim=axis)
def _gelu(x):
    return torch.nn.functional.gelu(x, approximate="tanh")
def _silu(x):
    return torch.nn.functional.silu(x)
def _sigmoid(x):
    return torch.sigmoid(x)
def _layernorm(x, axis=-1, eps=1e-5):
    m = x.mean(dim=axis, keepdim=True)
    v = x.var(dim=axis, keepdim=True, unbiased=False)
    return (x - m) / torch.sqrt(v + eps)
def _scatter_add(tgt, idx, src, axis=0):
    return tgt.clone().index_add_(axis, idx, src)
def _segment_sum(src, seg, n):
    out = torch.zeros((n,) + src.shape[1:], dtype=src.dtype)
    return out.index_add_(0, seg, src)
def _pad(x, pw):
    flat = tuple(v for pair in reversed(pw) for v in pair)
    return torch.nn.functional.pad(x, flat)

kernel_name = 'parallel_sum__gqa_block_cached__glu_gated_geglu__decode'

def setup_inputs():

    _w = (lambda a: (lambda t: t.to(torch.bfloat16) if t.is_floating_point() else t)(torch.as_tensor(a)))
    def _A_setup():
        B, Sq, D = 4, 1, 512
        Hq, Hkv, Sk, Dh = 32, 8, 4096, 128
        assert Hq % Hkv == 0, (Hq, Hkv)
        return {
            "x": _w((lambda *s: torch.randn(*s, dtype=torch.bfloat16) * 0.05)(B, Sq, D)),
            "k_cache": _w((lambda *s: torch.randn(*s, dtype=torch.bfloat16) * 1.6)(B, Hkv, Sk, Dh)),
            "v_cache": _w((lambda *s: torch.randn(*s, dtype=torch.bfloat16) * 0.8)(B, Hkv, Sk, Dh)),
            "wq": _w((lambda *s: torch.randn(*s, dtype=torch.bfloat16) * 1.6)(D, Hq * Dh) * (D ** -0.5)),
            "wo": _w((lambda *s: torch.randn(*s, dtype=torch.bfloat16) * 0.8)(Hq * Dh, D) * ((Hq * Dh) ** -0.5)),
        }
    _A_in = _A_setup()

    def _B_setup():
        B, S, Dm, Df = 4, 1, 512, 1792
        return {
            "x": _w((lambda *s: torch.randn(*s, dtype=torch.bfloat16) * 0.05)(B, S, Dm)),
            "w_gate": _w((lambda *s: torch.randn(*s, dtype=torch.bfloat16) * 0.4)(Dm, Df) * (Dm ** -0.5)),
            "w_up": _w((lambda *s: torch.randn(*s, dtype=torch.bfloat16) * 0.4)(Dm, Df) * (Dm ** -0.5)),
            "w_down": _w((lambda *s: torch.randn(*s, dtype=torch.bfloat16) * 0.4)(Df, Dm) * (Df ** -0.5)),
        }
    _B_in = _B_setup()

    return {
        "A_x": _A_in["x"],
        "A_k_cache": _A_in["k_cache"],
        "A_v_cache": _A_in["v_cache"],
        "A_wq": _A_in["wq"],
        "A_wo": _A_in["wo"],
        "B_x": _B_in["x"],
        "B_w_gate": _B_in["w_gate"],
        "B_w_up": _B_in["w_up"],
        "B_w_down": _B_in["w_down"],
    }

def reference(A_x, A_k_cache, A_v_cache, A_wq, A_wo, B_x, B_w_gate, B_w_up, B_w_down):
    def _A_ref(x, k_cache, v_cache, wq, wo):
        B, Sq, D = x.shape
        Hq, Dh = 32, 128
        Hkv = k_cache.shape[1]
        rep = Hq // Hkv
        q = (lambda x, *d: x.permute(*d))((x @ wq).reshape(B, Sq, Hq, Dh), 0, 2, 1, 3)
        k = (lambda x, n, axis: torch.repeat_interleave(x, n, dim=axis))(k_cache, rep, axis=1)
        v = (lambda x, n, axis: torch.repeat_interleave(x, n, dim=axis))(v_cache, rep, axis=1)
        scores = torch.einsum("bhqd,bhkd->bhqk", q, k) * (Dh ** -0.5)
        p = _softmax(scores, axis=-1)
        o = torch.einsum("bhqk,bhkd->bhqd", p, v)
        return (lambda x, *d: x.permute(*d))(o, 0, 2, 1, 3).reshape(B, Sq, Hq * Dh) @ wo

    def _B_ref(x, w_gate, w_up, w_down):
        g = torch.einsum("bsd,df->bsf", x, w_gate)
        u = torch.einsum("bsd,df->bsf", x, w_up)
        h = _gelu(g) * u
        return torch.einsum("bsf,fd->bsd", h, w_down)

    x = A_x
    xn = _layernorm(x, axis=-1)
    return x + _A_ref(xn, A_k_cache, A_v_cache, A_wq, A_wo) + _B_ref(xn, B_w_gate, B_w_up, B_w_down)
```

```asm
; @launch grid=(256,1,1) block=(512,1,1) lds=30208
.amdgcn_target "amdgcn-amd-amdhsa--gfx950"
.text
.globl parallel_sum__gqa_block_cached__glu_gated_geglu__decode_kernel
.p2align 8
.type parallel_sum__gqa_block_cached__glu_gated_geglu__decode_kernel,@function
parallel_sum__gqa_block_cached__glu_gated_geglu__decode_kernel:
  s_cmp_ge_u32 s2, 256
  s_cbranch_scc1 L_end
  s_load_dwordx16 s[16:31], s[0:1], 0
  s_load_dwordx8 s[32:39], s[0:1], 64
  v_and_b32 v1, 63, v0
  v_lshrrev_b32 v6, 6, v0
  v_lshrrev_b32 v2, 4, v1
  v_and_b32 v3, 15, v1
  v_readfirstlane_b32 s78, v6
  s_and_b32 s74, s2, 7
  s_lshr_b32 s75, s2, 3
  s_lshr_b32 s76, s75, 3
  s_and_b32 s77, s75, 7
  s_lshl_b32 s4, s76, 3
  s_add_u32 s4, s4, s74
  s_lshl_b32 s4, s4, 20
  s_lshl_b32 s5, s77, 17
  s_add_u32 s4, s4, s5
  s_lshl_b32 s5, s78, 14
  s_add_u32 s4, s4, s5
  v_lshlrev_b32 v5, 4, v1
  v_add_u32 v5, s4, v5
  v_and_b32 v6, 3, v3
  v_lshlrev_b32 v6, 2, v6
  v_bfe_u32 v7, v3, 2, 1
  v_add_u32 v6, v6, v7
  v_lshlrev_b32 v6, 8, v6
  v_lshrrev_b32 v7, 3, v3
  v_lshl_add_u32 v6, v7, 6, v6
  v_lshl_add_u32 v6, v2, 4, v6
  v_add_u32 v4, s4, v6
  v_mov_b32 v8, 0x3ff
  v_mov_b32 v9, 0
  v_mov_b32 v10, 0
  v_mov_b32 v11, 0
  ds_write_b64 v9, v[10:11] offset:0
  ds_write_b64 v9, v[10:11] offset:8
  ds_write_b64 v9, v[10:11] offset:16
  s_mov_b32 s9, 4096
  s_mov_b32 s10, 8192
  s_mov_b32 s11, 12288
  s_add_u32 s4, s78, 6
  s_and_b32 s4, s4, 7
  s_lshl_b32 s5, s4, 3
  s_mov_b32 s6, 0x0a060200
  s_mov_b32 s7, 0x1412160e
  s_lshr_b64 s[6:7], s[6:7], s5
  s_and_b32 s100, s6, 0xff
  s_mov_b32 s6, 0x100c0804
  s_mov_b32 s7, 0x1e1c1a18
  s_lshr_b64 s[6:7], s[6:7], s5
  s_and_b32 s101, s6, 0xff
  s_add_i32 s100, s100, -2
  s_add_i32 s101, s101, -2
  s_waitcnt lgkmcnt(0)
  s_mov_b32 s40, s18
  s_mov_b32 s41, s19
  s_mov_b32 s42, 33554432
  s_mov_b32 s43, 0x20000
  s_mov_b32 s44, s20
  s_mov_b32 s45, s21
  s_mov_b32 s46, 33554432
  s_mov_b32 s47, 0x20000
  s_mov_b32 s48, s38
  s_mov_b32 s49, s39
  s_mov_b32 s50, 4718592
  s_mov_b32 s51, 0x20000
  s_mov_b32 s60, s16
  s_mov_b32 s61, s17
  s_mov_b32 s62, 4096
  s_mov_b32 s63, 0x20000
  s_load_dwordx2 s[72:73], s[38:39], 0
  s_cmp_eq_u32 s78, 0
  s_cbranch_scc1 L_w0_pre
  s_cmp_eq_u32 s78, 1
  s_cbranch_scc1 L_w1_pre
  s_branch L_genbar
L_w0_pre:
  v_lshlrev_b32 v9, 4, v1
  buffer_load_dwordx4 v[144:147], v9, s[60:63], 0 offen offset:0
  buffer_load_dwordx4 v[148:151], v9, s[60:63], 0 offen offset:1024
  buffer_load_dwordx4 v[152:155], v9, s[60:63], 0 offen offset:2048
  buffer_load_dwordx4 v[156:159], v9, s[60:63], 0 offen offset:3072
  s_cmp_ge_u32 s75, 16
  s_cbranch_scc1 L_w0_gu
  s_mov_b32 s52, s22
  s_mov_b32 s53, s23
  s_mov_b32 s54, 4194304
  s_mov_b32 s55, 0x20000
  s_lshr_b32 s4, s75, 2
  s_lshl_b32 s4, s4, 20
  s_and_b32 s5, s75, 3
  s_lshl_b32 s5, s5, 8
  s_add_u32 s4, s4, s5
  s_lshl_b32 s5, s74, 10
  s_add_u32 s4, s4, s5
  v_lshlrev_b32 v10, 16, v2
  v_lshl_add_u32 v10, v3, 4, v10
  v_add_u32 v10, s4, v10
  s_mov_b32 s6, 0
  buffer_load_dwordx4 v[16:19], v10, s[52:55], s6 offen nt
  s_add_u32 s6, s6, 8192
  buffer_load_dwordx4 v[20:23], v10, s[52:55], s6 offen nt
  s_add_u32 s6, s6, 8192
  buffer_load_dwordx4 v[24:27], v10, s[52:55], s6 offen nt
  s_add_u32 s6, s6, 8192
  buffer_load_dwordx4 v[28:31], v10, s[52:55], s6 offen nt
  s_add_u32 s6, s6, 8192
  buffer_load_dwordx4 v[32:35], v10, s[52:55], s6 offen nt
  s_add_u32 s6, s6, 8192
  buffer_load_dwordx4 v[36:39], v10, s[52:55], s6 offen nt
  s_add_u32 s6, s6, 8192
  buffer_load_dwordx4 v[40:43], v10, s[52:55], s6 offen nt
  s_add_u32 s6, s6, 8192
  buffer_load_dwordx4 v[44:47], v10, s[52:55], s6 offen nt
  s_add_u32 s6, s6, 204800
  buffer_load_dwordx4 v[48:51], v10, s[52:55], s6 offen nt
  s_add_u32 s6, s6, 8192
  buffer_load_dwordx4 v[52:55], v10, s[52:55], s6 offen nt
  s_add_u32 s6, s6, 8192
  buffer_load_dwordx4 v[56:59], v10, s[52:55], s6 offen nt
  s_add_u32 s6, s6, 8192
  buffer_load_dwordx4 v[60:63], v10, s[52:55], s6 offen nt
  s_add_u32 s6, s6, 8192
  buffer_load_dwordx4 v[64:67], v10, s[52:55], s6 offen nt
  s_add_u32 s6, s6, 8192
  buffer_load_dwordx4 v[68:71], v10, s[52:55], s6 offen nt
  s_add_u32 s6, s6, 8192
  buffer_load_dwordx4 v[72:75], v10, s[52:55], s6 offen nt
  s_add_u32 s6, s6, 8192
  buffer_load_dwordx4 v[76:79], v10, s[52:55], s6 offen nt
  s_add_u32 s6, s6, 204800
  buffer_load_dwordx4 v[80:83], v10, s[52:55], s6 offen nt
  s_add_u32 s6, s6, 8192
  buffer_load_dwordx4 v[84:87], v10, s[52:55], s6 offen nt
  s_add_u32 s6, s6, 8192
  buffer_load_dwordx4 v[88:91], v10, s[52:55], s6 offen nt
  s_add_u32 s6, s6, 8192
  buffer_load_dwordx4 v[92:95], v10, s[52:55], s6 offen nt
  s_add_u32 s6, s6, 8192
  buffer_load_dwordx4 v[96:99], v10, s[52:55], s6 offen nt
  s_add_u32 s6, s6, 8192
  buffer_load_dwordx4 v[100:103], v10, s[52:55], s6 offen nt
  s_add_u32 s6, s6, 8192
  buffer_load_dwordx4 v[104:107], v10, s[52:55], s6 offen nt
  s_add_u32 s6, s6, 8192
  buffer_load_dwordx4 v[108:111], v10, s[52:55], s6 offen nt
  s_add_u32 s6, s6, 204800
  buffer_load_dwordx4 v[112:115], v10, s[52:55], s6 offen nt
  s_add_u32 s6, s6, 8192
  buffer_load_dwordx4 v[116:119], v10, s[52:55], s6 offen nt
  s_add_u32 s6, s6, 8192
  buffer_load_dwordx4 v[120:123], v10, s[52:55], s6 offen nt
  s_add_u32 s6, s6, 8192
  buffer_load_dwordx4 v[124:127], v10, s[52:55], s6 offen nt
  s_add_u32 s6, s6, 8192
  buffer_load_dwordx4 v[128:131], v10, s[52:55], s6 offen nt
  s_add_u32 s6, s6, 8192
  buffer_load_dwordx4 v[132:135], v10, s[52:55], s6 offen nt
  s_add_u32 s6, s6, 8192
  buffer_load_dwordx4 v[136:139], v10, s[52:55], s6 offen nt
  s_add_u32 s6, s6, 8192
  buffer_load_dwordx4 v[140:143], v10, s[52:55], s6 offen nt
  s_barrier
  s_waitcnt vmcnt(32)
  v_lshlrev_b32 v176, 16, v144
  v_and_b32 v177, 0xffff0000, v144
  v_lshlrev_b32 v178, 16, v145
  v_and_b32 v179, 0xffff0000, v145
  v_lshlrev_b32 v180, 16, v146
  v_and_b32 v181, 0xffff0000, v146
  v_lshlrev_b32 v182, 16, v147
  v_and_b32 v183, 0xffff0000, v147
  v_lshlrev_b32 v184, 16, v148
  v_and_b32 v185, 0xffff0000, v148
  v_lshlrev_b32 v186, 16, v149
  v_and_b32 v187, 0xffff0000, v149
  v_lshlrev_b32 v188, 16, v150
  v_and_b32 v189, 0xffff0000, v150
  v_lshlrev_b32 v190, 16, v151
  v_and_b32 v191, 0xffff0000, v151
  v_lshlrev_b32 v192, 16, v152
  v_and_b32 v193, 0xffff0000, v152
  v_lshlrev_b32 v194, 16, v153
  v_and_b32 v195, 0xffff0000, v153
  v_lshlrev_b32 v196, 16, v154
  v_and_b32 v197, 0xffff0000, v154
  v_lshlrev_b32 v198, 16, v155
  v_and_b32 v199, 0xffff0000, v155
  v_lshlrev_b32 v200, 16, v156
  v_and_b32 v201, 0xffff0000, v156
  v_lshlrev_b32 v202, 16, v157
  v_and_b32 v203, 0xffff0000, v157
  v_lshlrev_b32 v204, 16, v158
  v_and_b32 v205, 0xffff0000, v158
  v_lshlrev_b32 v206, 16, v159
  v_and_b32 v207, 0xffff0000, v159
  v_add_f32 v208, v176, v177
  v_mul_f32 v212, v176, v176
  v_add_f32 v209, v184, v185
  v_mul_f32 v213, v184, v184
  v_add_f32 v210, v192, v193
  v_mul_f32 v214, v192, v192
  v_add_f32 v211, v200, v201
  v_mul_f32 v215, v200, v200
  v_fmac_f32 v212, v177, v177
  v_fmac_f32 v213, v185, v185
  v_fmac_f32 v214, v193, v193
  v_fmac_f32 v215, v201, v201
  v_add_f32 v208, v208, v178
  v_fmac_f32 v212, v178, v178
  v_add_f32 v209, v209, v186
  v_fmac_f32 v213, v186, v186
  v_add_f32 v210, v210, v194
  v_fmac_f32 v214, v194, v194
  v_add_f32 v211, v211, v202
  v_fmac_f32 v215, v202, v202
  v_add_f32 v208, v208, v179
  v_fmac_f32 v212, v179, v179
  v_add_f32 v209, v209, v187
  v_fmac_f32 v213, v187, v187
  v_add_f32 v210, v210, v195
  v_fmac_f32 v214, v195, v195
  v_add_f32 v211, v211, v203
  v_fmac_f32 v215, v203, v203
  v_add_f32 v208, v208, v180
  v_fmac_f32 v212, v180, v180
  v_add_f32 v209, v209, v188
  v_fmac_f32 v213, v188, v188
  v_add_f32 v210, v210, v196
  v_fmac_f32 v214, v196, v196
  v_add_f32 v211, v211, v204
  v_fmac_f32 v215, v204, v204
  v_add_f32 v208, v208, v181
  v_fmac_f32 v212, v181, v181
  v_add_f32 v209, v209, v189
  v_fmac_f32 v213, v189, v189
  v_add_f32 v210, v210, v197
  v_fmac_f32 v214, v197, v197
  v_add_f32 v211, v211, v205
  v_fmac_f32 v215, v205, v205
  v_add_f32 v208, v208, v182
  v_fmac_f32 v212, v182, v182
  v_add_f32 v209, v209, v190
  v_fmac_f32 v213, v190, v190
  v_add_f32 v210, v210, v198
  v_fmac_f32 v214, v198, v198
  v_add_f32 v211, v211, v206
  v_fmac_f32 v215, v206, v206
  v_add_f32 v208, v208, v183
  v_fmac_f32 v212, v183, v183
  v_add_f32 v209, v209, v191
  v_fmac_f32 v213, v191, v191
  v_add_f32 v210, v210, v199
  v_fmac_f32 v214, v199, v199
  v_add_f32 v211, v211, v207
  v_fmac_f32 v215, v207, v207
  v_add_f32_dpp v208, v208, v208 row_shr:1 row_mask:0xf bank_mask:0xf bound_ctrl:0
  v_add_f32_dpp v209, v209, v209 row_shr:1 row_mask:0xf bank_mask:0xf bound_ctrl:0
  v_add_f32_dpp v210, v210, v210 row_shr:1 row_mask:0xf bank_mask:0xf bound_ctrl:0
  v_add_f32_dpp v211, v211, v211 row_shr:1 row_mask:0xf bank_mask:0xf bound_ctrl:0
  v_add_f32_dpp v212, v212, v212 row_shr:1 row_mask:0xf bank_mask:0xf bound_ctrl:0
  v_add_f32_dpp v213, v213, v213 row_shr:1 row_mask:0xf bank_mask:0xf bound_ctrl:0
  v_add_f32_dpp v214, v214, v214 row_shr:1 row_mask:0xf bank_mask:0xf bound_ctrl:0
  v_add_f32_dpp v215, v215, v215 row_shr:1 row_mask:0xf bank_mask:0xf bound_ctrl:0
  v_add_f32_dpp v208, v208, v208 row_shr:2 row_mask:0xf bank_mask:0xf bound_ctrl:0
  v_add_f32_dpp v209, v209, v209 row_shr:2 row_mask:0xf bank_mask:0xf bound_ctrl:0
  v_add_f32_dpp v210, v210, v210 row_shr:2 row_mask:0xf bank_mask:0xf bound_ctrl:0
  v_add_f32_dpp v211, v211, v211 row_shr:2 row_mask:0xf bank_mask:0xf bound_ctrl:0
  v_add_f32_dpp v212, v212, v212 row_shr:2 row_mask:0xf bank_mask:0xf bound_ctrl:0
  v_add_f32_dpp v213, v213, v213 row_shr:2 row_mask:0xf bank_mask:0xf bound_ctrl:0
  v_add_f32_dpp v214, v214, v214 row_shr:2 row_mask:0xf bank_mask:0xf bound_ctrl:0
  v_add_f32_dpp v215, v215, v215 row_shr:2 row_mask:0xf bank_mask:0xf bound_ctrl:0
  v_add_f32_dpp v208, v208, v208 row_shr:4 row_mask:0xf bank_mask:0xf bound_ctrl:0
  v_add_f32_dpp v209, v209, v209 row_shr:4 row_mask:0xf bank_mask:0xf bound_ctrl:0
  v_add_f32_dpp v210, v210, v210 row_shr:4 row_mask:0xf bank_mask:0xf bound_ctrl:0
  v_add_f32_dpp v211, v211, v211 row_shr:4 row_mask:0xf bank_mask:0xf bound_ctrl:0
  v_add_f32_dpp v212, v212, v212 row_shr:4 row_mask:0xf bank_mask:0xf bound_ctrl:0
  v_add_f32_dpp v213, v213, v213 row_shr:4 row_mask:0xf bank_mask:0xf bound_ctrl:0
  v_add_f32_dpp v214, v214, v214 row_shr:4 row_mask:0xf bank_mask:0xf bound_ctrl:0
  v_add_f32_dpp v215, v215, v215 row_shr:4 row_mask:0xf bank_mask:0xf bound_ctrl:0
  v_add_f32_dpp v208, v208, v208 row_shr:8 row_mask:0xf bank_mask:0xf bound_ctrl:0
  v_add_f32_dpp v209, v209, v209 row_shr:8 row_mask:0xf bank_mask:0xf bound_ctrl:0
  v_add_f32_dpp v210, v210, v210 row_shr:8 row_mask:0xf bank_mask:0xf bound_ctrl:0
  v_add_f32_dpp v211, v211, v211 row_shr:8 row_mask:0xf bank_mask:0xf bound_ctrl:0
  v_add_f32_dpp v212, v212, v212 row_shr:8 row_mask:0xf bank_mask:0xf bound_ctrl:0
  v_add_f32_dpp v213, v213, v213 row_shr:8 row_mask:0xf bank_mask:0xf bound_ctrl:0
  v_add_f32_dpp v214, v214, v214 row_shr:8 row_mask:0xf bank_mask:0xf bound_ctrl:0
  v_add_f32_dpp v215, v215, v215 row_shr:8 row_mask:0xf bank_mask:0xf bound_ctrl:0
  v_add_f32_dpp v208, v208, v208 row_bcast:15 row_mask:0xa bank_mask:0xf
  v_add_f32_dpp v209, v209, v209 row_bcast:15 row_mask:0xa bank_mask:0xf
  v_add_f32_dpp v210, v210, v210 row_bcast:15 row_mask:0xa bank_mask:0xf
  v_add_f32_dpp v211, v211, v211 row_bcast:15 row_mask:0xa bank_mask:0xf
  v_add_f32_dpp v212, v212, v212 row_bcast:15 row_mask:0xa bank_mask:0xf
  v_add_f32_dpp v213, v213, v213 row_bcast:15 row_mask:0xa bank_mask:0xf
  v_add_f32_dpp v214, v214, v214 row_bcast:15 row_mask:0xa bank_mask:0xf
  v_add_f32_dpp v215, v215, v215 row_bcast:15 row_mask:0xa bank_mask:0xf
  v_add_f32_dpp v208, v208, v208 row_bcast:31 row_mask:0xc bank_mask:0xf
  v_add_f32_dpp v209, v209, v209 row_bcast:31 row_mask:0xc bank_mask:0xf
  v_add_f32_dpp v210, v210, v210 row_bcast:31 row_mask:0xc bank_mask:0xf
  v_add_f32_dpp v211, v211, v211 row_bcast:31 row_mask:0xc bank_mask:0xf
  v_add_f32_dpp v212, v212, v212 row_bcast:31 row_mask:0xc bank_mask:0xf
  v_add_f32_dpp v213, v213, v213 row_bcast:31 row_mask:0xc bank_mask:0xf
  v_add_f32_dpp v214, v214, v214 row_bcast:31 row_mask:0xc bank_mask:0xf
  v_add_f32_dpp v215, v215, v215 row_bcast:31 row_mask:0xc bank_mask:0xf
  v_readlane_b32 s12, v208, 63
  v_readlane_b32 s13, v209, 63
  v_readlane_b32 s14, v210, 63
  v_readlane_b32 s15, v211, 63
  v_readlane_b32 s26, v212, 63
  v_readlane_b32 s27, v213, 63
  v_readlane_b32 s4, v214, 63
  v_readlane_b32 s5, v215, 63
  v_mov_b32 v224, 0x3b000000
  v_mul_f32 v216, s12, v224
  v_mul_f32 v220, s26, v224
  v_fma_f32 v220, -v216, v216, v220
  v_cvt_pk_bf16_f32 v216, v216, v220
  v_and_b32 v220, 0xffff0000, v216
  v_lshlrev_b32 v216, 16, v216
  v_add_f32 v220, 0x3727c5ac, v220
  v_cvt_pk_bf16_f32 v220, v220, v220
  v_lshlrev_b32 v220, 16, v220
  v_sqrt_f32 v220, v220
  s_nop 0
  v_cvt_pk_bf16_f32 v220, v220, v220
  v_lshlrev_b32 v220, 16, v220
  v_rcp_f32 v220, v220
  v_mov_b32 v225, 0x3b000000
  v_mul_f32 v217, s13, v225
  v_mul_f32 v221, s27, v225
  v_fma_f32 v221, -v217, v217, v221
  v_cvt_pk_bf16_f32 v217, v217, v221
  v_and_b32 v221, 0xffff0000, v217
  v_lshlrev_b32 v217, 16, v217
  v_add_f32 v221, 0x3727c5ac, v221
  v_cvt_pk_bf16_f32 v221, v221, v221
  v_lshlrev_b32 v221, 16, v221
  v_sqrt_f32 v221, v221
  s_nop 0
  v_cvt_pk_bf16_f32 v221, v221, v221
  v_lshlrev_b32 v221, 16, v221
  v_rcp_f32 v221, v221
  v_mov_b32 v226, 0x3b000000
  v_mul_f32 v218, s14, v226
  v_mul_f32 v222, s4, v226
  v_fma_f32 v222, -v218, v218, v222
  v_cvt_pk_bf16_f32 v218, v218, v222
  v_and_b32 v222, 0xffff0000, v218
  v_lshlrev_b32 v218, 16, v218
  v_add_f32 v222, 0x3727c5ac, v222
  v_cvt_pk_bf16_f32 v222, v222, v222
  v_lshlrev_b32 v222, 16, v222
  v_sqrt_f32 v222, v222
  s_nop 0
  v_cvt_pk_bf16_f32 v222, v222, v222
  v_lshlrev_b32 v222, 16, v222
  v_rcp_f32 v222, v222
  v_mov_b32 v227, 0x3b000000
  v_mul_f32 v219, s15, v227
  v_mul_f32 v223, s5, v227
  v_fma_f32 v223, -v219, v219, v223
  v_cvt_pk_bf16_f32 v219, v219, v223
  v_and_b32 v223, 0xffff0000, v219
  v_lshlrev_b32 v219, 16, v219
  v_add_f32 v223, 0x3727c5ac, v223
  v_cvt_pk_bf16_f32 v223, v223, v223
  v_lshlrev_b32 v223, 16, v223
  v_sqrt_f32 v223, v223
  s_nop 0
  v_cvt_pk_bf16_f32 v223, v223, v223
  v_lshlrev_b32 v223, 16, v223
  v_rcp_f32 v223, v223
  v_sub_f32 v176, v176, v216
  v_sub_f32 v177, v177, v216
  v_cvt_pk_bf16_f32 v177, v176, v177
  v_lshlrev_b32 v176, 16, v177
  v_and_b32 v177, 0xffff0000, v177
  v_mul_f32 v176, v176, v220
  v_mul_f32 v177, v177, v220
  v_cvt_pk_bf16_f32 v144, v176, v177
  v_sub_f32 v178, v178, v216
  v_sub_f32 v179, v179, v216
  v_cvt_pk_bf16_f32 v179, v178, v179
  v_lshlrev_b32 v178, 16, v179
  v_and_b32 v179, 0xffff0000, v179
  v_mul_f32 v178, v178, v220
  v_mul_f32 v179, v179, v220
  v_cvt_pk_bf16_f32 v145, v178, v179
  v_sub_f32 v180, v180, v216
  v_sub_f32 v181, v181, v216
  v_cvt_pk_bf16_f32 v181, v180, v181
  v_lshlrev_b32 v180, 16, v181
  v_and_b32 v181, 0xffff0000, v181
  v_mul_f32 v180, v180, v220
  v_mul_f32 v181, v181, v220
  v_cvt_pk_bf16_f32 v146, v180, v181
  v_sub_f32 v182, v182, v216
  v_sub_f32 v183, v183, v216
  v_cvt_pk_bf16_f32 v183, v182, v183
  v_lshlrev_b32 v182, 16, v183
  v_and_b32 v183, 0xffff0000, v183
  v_mul_f32 v182, v182, v220
  v_mul_f32 v183, v183, v220
  v_cvt_pk_bf16_f32 v147, v182, v183
  v_sub_f32 v184, v184, v217
  v_sub_f32 v185, v185, v217
  v_cvt_pk_bf16_f32 v185, v184, v185
  v_lshlrev_b32 v184, 16, v185
  v_and_b32 v185, 0xffff0000, v185
  v_mul_f32 v184, v184, v221
  v_mul_f32 v185, v185, v221
  v_cvt_pk_bf16_f32 v148, v184, v185
  v_sub_f32 v186, v186, v217
  v_sub_f32 v187, v187, v217
  v_cvt_pk_bf16_f32 v187, v186, v187
  v_lshlrev_b32 v186, 16, v187
  v_and_b32 v187, 0xffff0000, v187
  v_mul_f32 v186, v186, v221
  v_mul_f32 v187, v187, v221
  v_cvt_pk_bf16_f32 v149, v186, v187
  v_sub_f32 v188, v188, v217
  v_sub_f32 v189, v189, v217
  v_cvt_pk_bf16_f32 v189, v188, v189
  v_lshlrev_b32 v188, 16, v189
  v_and_b32 v189, 0xffff0000, v189
  v_mul_f32 v188, v188, v221
  v_mul_f32 v189, v189, v221
  v_cvt_pk_bf16_f32 v150, v188, v189
  v_sub_f32 v190, v190, v217
  v_sub_f32 v191, v191, v217
  v_cvt_pk_bf16_f32 v191, v190, v191
  v_lshlrev_b32 v190, 16, v191
  v_and_b32 v191, 0xffff0000, v191
  v_mul_f32 v190, v190, v221
  v_mul_f32 v191, v191, v221
  v_cvt_pk_bf16_f32 v151, v190, v191
  v_sub_f32 v192, v192, v218
  v_sub_f32 v193, v193, v218
  v_cvt_pk_bf16_f32 v193, v192, v193
  v_lshlrev_b32 v192, 16, v193
  v_and_b32 v193, 0xffff0000, v193
  v_mul_f32 v192, v192, v222
  v_mul_f32 v193, v193, v222
  v_cvt_pk_bf16_f32 v152, v192, v193
  v_sub_f32 v194, v194, v218
  v_sub_f32 v195, v195, v218
  v_cvt_pk_bf16_f32 v195, v194, v195
  v_lshlrev_b32 v194, 16, v195
  v_and_b32 v195, 0xffff0000, v195
  v_mul_f32 v194, v194, v222
  v_mul_f32 v195, v195, v222
  v_cvt_pk_bf16_f32 v153, v194, v195
  v_sub_f32 v196, v196, v218
  v_sub_f32 v197, v197, v218
  v_cvt_pk_bf16_f32 v197, v196, v197
  v_lshlrev_b32 v196, 16, v197
  v_and_b32 v197, 0xffff0000, v197
  v_mul_f32 v196, v196, v222
  v_mul_f32 v197, v197, v222
  v_cvt_pk_bf16_f32 v154, v196, v197
  v_sub_f32 v198, v198, v218
  v_sub_f32 v199, v199, v218
  v_cvt_pk_bf16_f32 v199, v198, v199
  v_lshlrev_b32 v198, 16, v199
  v_and_b32 v199, 0xffff0000, v199
  v_mul_f32 v198, v198, v222
  v_mul_f32 v199, v199, v222
  v_cvt_pk_bf16_f32 v155, v198, v199
  v_sub_f32 v200, v200, v219
  v_sub_f32 v201, v201, v219
  v_cvt_pk_bf16_f32 v201, v200, v201
  v_lshlrev_b32 v200, 16, v201
  v_and_b32 v201, 0xffff0000, v201
  v_mul_f32 v200, v200, v223
  v_mul_f32 v201, v201, v223
  v_cvt_pk_bf16_f32 v156, v200, v201
  v_sub_f32 v202, v202, v219
  v_sub_f32 v203, v203, v219
  v_cvt_pk_bf16_f32 v203, v202, v203
  v_lshlrev_b32 v202, 16, v203
  v_and_b32 v203, 0xffff0000, v203
  v_mul_f32 v202, v202, v223
  v_mul_f32 v203, v203, v223
  v_cvt_pk_bf16_f32 v157, v202, v203
  v_sub_f32 v204, v204, v219
  v_sub_f32 v205, v205, v219
  v_cvt_pk_bf16_f32 v205, v204, v205
  v_lshlrev_b32 v204, 16, v205
  v_and_b32 v205, 0xffff0000, v205
  v_mul_f32 v204, v204, v223
  v_mul_f32 v205, v205, v223
  v_cvt_pk_bf16_f32 v158, v204, v205
  v_sub_f32 v206, v206, v219
  v_sub_f32 v207, v207, v219
  v_cvt_pk_bf16_f32 v207, v206, v207
  v_lshlrev_b32 v206, 16, v207
  v_and_b32 v207, 0xffff0000, v207
  v_mul_f32 v206, v206, v223
  v_mul_f32 v207, v207, v223
  v_cvt_pk_bf16_f32 v159, v206, v207
  v_lshlrev_b32 v9, 4, v1
  ds_write_b128 v9, v[144:147] offset:1408
  ds_write_b128 v9, v[148:151] offset:2496
  ds_write_b128 v9, v[152:155] offset:3584
  ds_write_b128 v9, v[156:159] offset:4672
  s_lshr_b32 s4, s75, 2
  s_lshl_b32 s4, s4, 8
  v_and_b32 v9, 3, v3
  v_mul_u32_u24 v9, 1088, v9
  v_lshl_add_u32 v9, v2, 4, v9
  v_add_u32 v9, s4, v9
  s_waitcnt lgkmcnt(0)
  ds_read_b128 v[240:243], v9 offset:1408
  ds_read_b128 v[244:247], v9 offset:1472
  ds_read_b128 v[248:251], v9 offset:1536
  ds_read_b128 v[252:255], v9 offset:1600
  s_mov_b32 s80, 0x05040100
  s_mov_b32 s81, 0x07060302
  s_mov_b32 s12, 0x00f000f0
  s_mov_b32 s13, 0x00f000f0
  s_mov_b32 s14, 0x0f000f00
  s_mov_b32 s15, 0x0f000f00
  s_mov_b32 s26, 0xf000f000
  s_mov_b32 s27, 0xf000f000
  s_waitcnt vmcnt(24)
  v_perm_b32 v144, v20, v16, s80
  v_perm_b32 v148, v20, v16, s81
  v_perm_b32 v152, v21, v17, s80
  v_perm_b32 v156, v21, v17, s81
  v_perm_b32 v160, v22, v18, s80
  v_perm_b32 v164, v22, v18, s81
  v_perm_b32 v168, v23, v19, s80
  v_perm_b32 v172, v23, v19, s81
  v_perm_b32 v145, v28, v24, s80
  v_perm_b32 v149, v28, v24, s81
  v_perm_b32 v153, v29, v25, s80
  v_perm_b32 v157, v29, v25, s81
  v_perm_b32 v161, v30, v26, s80
  v_perm_b32 v165, v30, v26, s81
  v_perm_b32 v169, v31, v27, s80
  v_perm_b32 v173, v31, v27, s81
  v_perm_b32 v146, v36, v32, s80
  v_perm_b32 v150, v36, v32, s81
  v_perm_b32 v154, v37, v33, s80
  v_perm_b32 v158, v37, v33, s81
  v_perm_b32 v162, v38, v34, s80
  v_perm_b32 v166, v38, v34, s81
  v_perm_b32 v170, v39, v35, s80
  v_perm_b32 v174, v39, v35, s81
  v_perm_b32 v147, v44, v40, s80
  v_perm_b32 v151, v44, v40, s81
  v_perm_b32 v155, v45, v41, s80
  v_perm_b32 v159, v45, v41, s81
  v_perm_b32 v163, v46, v42, s80
  v_perm_b32 v167, v46, v42, s81
  v_perm_b32 v171, v47, v43, s80
  v_perm_b32 v175, v47, v43, s81
  s_waitcnt lgkmcnt(0)
  v_mfma_f32_16x16x32_bf16 v[176:179], v[144:147], v[240:243], 0
  v_mfma_f32_16x16x32_bf16 v[180:183], v[148:151], v[240:243], 0
  v_mfma_f32_16x16x32_bf16 v[184:187], v[152:155], v[240:243], 0
  v_mfma_f32_16x16x32_bf16 v[188:191], v[156:159], v[240:243], 0
  v_mfma_f32_16x16x32_bf16 v[192:195], v[160:163], v[240:243], 0
  v_mfma_f32_16x16x32_bf16 v[196:199], v[164:167], v[240:243], 0
  v_mfma_f32_16x16x32_bf16 v[200:203], v[168:171], v[240:243], 0
  v_mfma_f32_16x16x32_bf16 v[204:207], v[172:175], v[240:243], 0
  s_waitcnt vmcnt(16)
  v_perm_b32 v144, v52, v48, s80
  v_perm_b32 v148, v52, v48, s81
  v_perm_b32 v152, v53, v49, s80
  v_perm_b32 v156, v53, v49, s81
  v_perm_b32 v160, v54, v50, s80
  v_perm_b32 v164, v54, v50, s81
  v_perm_b32 v168, v55, v51, s80
  v_perm_b32 v172, v55, v51, s81
  v_perm_b32 v145, v60, v56, s80
  v_perm_b32 v149, v60, v56, s81
  v_perm_b32 v153, v61, v57, s80
  v_perm_b32 v157, v61, v57, s81
  v_perm_b32 v161, v62, v58, s80
  v_perm_b32 v165, v62, v58, s81
  v_perm_b32 v169, v63, v59, s80
  v_perm_b32 v173, v63, v59, s81
  v_perm_b32 v146, v68, v64, s80
  v_perm_b32 v150, v68, v64, s81
  v_perm_b32 v154, v69, v65, s80
  v_perm_b32 v158, v69, v65, s81
  v_perm_b32 v162, v70, v66, s80
  v_perm_b32 v166, v70, v66, s81
  v_perm_b32 v170, v71, v67, s80
  v_perm_b32 v174, v71, v67, s81
  v_perm_b32 v147, v76, v72, s80
  v_perm_b32 v151, v76, v72, s81
  v_perm_b32 v155, v77, v73, s80
  v_perm_b32 v159, v77, v73, s81
  v_perm_b32 v163, v78, v74, s80
  v_perm_b32 v167, v78, v74, s81
  v_perm_b32 v171, v79, v75, s80
  v_perm_b32 v175, v79, v75, s81
  v_mfma_f32_16x16x32_bf16 v[176:179], v[144:147], v[244:247], v[176:179]
  v_mfma_f32_16x16x32_bf16 v[180:183], v[148:151], v[244:247], v[180:183]
  v_mfma_f32_16x16x32_bf16 v[184:187], v[152:155], v[244:247], v[184:187]
  v_mfma_f32_16x16x32_bf16 v[188:191], v[156:159], v[244:247], v[188:191]
  v_mfma_f32_16x16x32_bf16 v[192:195], v[160:163], v[244:247], v[192:195]
  v_mfma_f32_16x16x32_bf16 v[196:199], v[164:167], v[244:247], v[196:199]
  v_mfma_f32_16x16x32_bf16 v[200:203], v[168:171], v[244:247], v[200:203]
  v_mfma_f32_16x16x32_bf16 v[204:207], v[172:175], v[244:247], v[204:207]
  s_waitcnt vmcnt(8)
  v_perm_b32 v144, v84, v80, s80
  v_perm_b32 v148, v84, v80, s81
  v_perm_b32 v152, v85, v81, s80
  v_perm_b32 v156, v85, v81, s81
  v_perm_b32 v160, v86, v82, s80
  v_perm_b32 v164, v86, v82, s81
  v_perm_b32 v168, v87, v83, s80
  v_perm_b32 v172, v87, v83, s81
  v_perm_b32 v145, v92, v88, s80
  v_perm_b32 v149, v92, v88, s81
  v_perm_b32 v153, v93, v89, s80
  v_perm_b32 v157, v93, v89, s81
  v_perm_b32 v161, v94, v90, s80
  v_perm_b32 v165, v94, v90, s81
  v_perm_b32 v169, v95, v91, s80
  v_perm_b32 v173, v95, v91, s81
  v_perm_b32 v146, v100, v96, s80
  v_perm_b32 v150, v100, v96, s81
  v_perm_b32 v154, v101, v97, s80
  v_perm_b32 v158, v101, v97, s81
  v_perm_b32 v162, v102, v98, s80
  v_perm_b32 v166, v102, v98, s81
  v_perm_b32 v170, v103, v99, s80
  v_perm_b32 v174, v103, v99, s81
  v_perm_b32 v147, v108, v104, s80
  v_perm_b32 v151, v108, v104, s81
  v_perm_b32 v155, v109, v105, s80
  v_perm_b32 v159, v109, v105, s81
  v_perm_b32 v163, v110, v106, s80
  v_perm_b32 v167, v110, v106, s81
  v_perm_b32 v171, v111, v107, s80
  v_perm_b32 v175, v111, v107, s81
  v_mfma_f32_16x16x32_bf16 v[176:179], v[144:147], v[248:251], v[176:179]
  v_mfma_f32_16x16x32_bf16 v[180:183], v[148:151], v[248:251], v[180:183]
  v_mfma_f32_16x16x32_bf16 v[184:187], v[152:155], v[248:251], v[184:187]
  v_mfma_f32_16x16x32_bf16 v[188:191], v[156:159], v[248:251], v[188:191]
  v_mfma_f32_16x16x32_bf16 v[192:195], v[160:163], v[248:251], v[192:195]
  v_mfma_f32_16x16x32_bf16 v[196:199], v[164:167], v[248:251], v[196:199]
  v_mfma_f32_16x16x32_bf16 v[200:203], v[168:171], v[248:251], v[200:203]
  v_mfma_f32_16x16x32_bf16 v[204:207], v[172:175], v[248:251], v[204:207]
  s_waitcnt vmcnt(0)
  v_perm_b32 v144, v116, v112, s80
  v_perm_b32 v148, v116, v112, s81
  v_perm_b32 v152, v117, v113, s80
  v_perm_b32 v156, v117, v113, s81
  v_perm_b32 v160, v118, v114, s80
  v_perm_b32 v164, v118, v114, s81
  v_perm_b32 v168, v119, v115, s80
  v_perm_b32 v172, v119, v115, s81
  v_perm_b32 v145, v124, v120, s80
  v_perm_b32 v149, v124, v120, s81
  v_perm_b32 v153, v125, v121, s80
  v_perm_b32 v157, v125, v121, s81
  v_perm_b32 v161, v126, v122, s80
  v_perm_b32 v165, v126, v122, s81
  v_perm_b32 v169, v127, v123, s80
  v_perm_b32 v173, v127, v123, s81
  v_perm_b32 v146, v132, v128, s80
  v_perm_b32 v150, v132, v128, s81
  v_perm_b32 v154, v133, v129, s80
  v_perm_b32 v158, v133, v129, s81
  v_perm_b32 v162, v134, v130, s80
  v_perm_b32 v166, v134, v130, s81
  v_perm_b32 v170, v135, v131, s80
  v_perm_b32 v174, v135, v131, s81
  v_perm_b32 v147, v140, v136, s80
  v_perm_b32 v151, v140, v136, s81
  v_perm_b32 v155, v141, v137, s80
  v_perm_b32 v159, v141, v137, s81
  v_perm_b32 v163, v142, v138, s80
  v_perm_b32 v167, v142, v138, s81
  v_perm_b32 v171, v143, v139, s80
  v_perm_b32 v175, v143, v139, s81
  v_mfma_f32_16x16x32_bf16 v[176:179], v[144:147], v[252:255], v[176:179]
  v_mfma_f32_16x16x32_bf16 v[180:183], v[148:151], v[252:255], v[180:183]
  v_mfma_f32_16x16x32_bf16 v[184:187], v[152:155], v[252:255], v[184:187]
  v_mfma_f32_16x16x32_bf16 v[188:191], v[156:159], v[252:255], v[188:191]
  v_mfma_f32_16x16x32_bf16 v[192:195], v[160:163], v[252:255], v[192:195]
  v_mfma_f32_16x16x32_bf16 v[196:199], v[164:167], v[252:255], v[196:199]
  v_mfma_f32_16x16x32_bf16 v[200:203], v[168:171], v[252:255], v[200:203]
  v_mfma_f32_16x16x32_bf16 v[204:207], v[172:175], v[252:255], v[204:207]
  s_waitcnt lgkmcnt(0)
  s_add_u32 s72, s72, 0x00100401
  s_add_u32 s73, s73, 1
  s_and_b32 s68, s72, 0x3ff
  s_bfe_u32 s69, s72, 0xa000a
  s_bfe_u32 s70, s72, 0xa0014
  s_and_b32 s71, s73, 0x3ff
  s_lshl_b32 s4, s74, 15
  s_lshr_b32 s5, s75, 2
  s_lshl_b32 s5, s5, 11
  s_add_u32 s4, s4, s5
  s_and_b32 s5, s75, 3
  s_lshl_b32 s5, s5, 9
  s_add_u32 s4, s4, s5
  s_add_u32 s4, s4, 65536
  v_and_b32 v9, 3, v3
  v_lshlrev_b32 v9, 13, v9
  v_lshrrev_b32 v10, 2, v3
  v_lshl_add_u32 v9, v10, 6, v9
  v_lshl_add_u32 v9, v2, 4, v9
  v_add_u32 v11, s4, v9
  v_cndmask_b32 v144, v176, v177, s[12:13]
  v_cndmask_b32 v145, v180, v181, s[12:13]
  v_cndmask_b32 v146, v184, v185, s[12:13]
  v_cndmask_b32 v147, v188, v189, s[12:13]
  v_cndmask_b32 v148, v192, v193, s[12:13]
  v_cndmask_b32 v149, v196, v197, s[12:13]
  v_cndmask_b32 v150, v200, v201, s[12:13]
  v_cndmask_b32 v151, v204, v205, s[12:13]
  v_cndmask_b32 v144, v144, v178, s[14:15]
  v_cndmask_b32 v145, v145, v182, s[14:15]
  v_cndmask_b32 v146, v146, v186, s[14:15]
  v_cndmask_b32 v147, v147, v190, s[14:15]
  v_cndmask_b32 v148, v148, v194, s[14:15]
  v_cndmask_b32 v149, v149, v198, s[14:15]
  v_cndmask_b32 v150, v150, v202, s[14:15]
  v_cndmask_b32 v151, v151, v206, s[14:15]
  v_cndmask_b32 v144, v144, v179, s[26:27]
  v_cndmask_b32 v145, v145, v183, s[26:27]
  v_cndmask_b32 v146, v146, v187, s[26:27]
  v_cndmask_b32 v147, v147, v191, s[26:27]
  v_cndmask_b32 v148, v148, v195, s[26:27]
  v_cndmask_b32 v149, v149, v199, s[26:27]
  v_cndmask_b32 v150, v150, v203, s[26:27]
  v_cndmask_b32 v151, v151, v207, s[26:27]
  v_bfi_b32 v144, v8, s68, v144
  v_bfi_b32 v145, v8, s69, v145
  v_bfi_b32 v146, v8, s70, v146
  v_bfi_b32 v147, v8, s71, v147
  v_bfi_b32 v148, v8, s68, v148
  v_bfi_b32 v149, v8, s69, v149
  v_bfi_b32 v150, v8, s70, v150
  v_bfi_b32 v151, v8, s71, v151
  s_mov_b32 s3, 256
  s_mov_b32 s7, 1
  s_branch L_w0_pub
L_w0_gu:
  s_cmp_ge_u32 s74, 7
  s_cbranch_scc1 L_w0_none
  s_mov_b32 s52, s28
  s_mov_b32 s53, s29
  s_mov_b32 s54, 1835008
  s_mov_b32 s55, 0x20000
  s_mov_b32 s56, s30
  s_mov_b32 s57, s31
  s_mov_b32 s58, 1835008
  s_mov_b32 s59, 0x20000
  s_and_b32 s3, s75, 7
  s_bfe_u32 s7, s75, 0x10003
  s_lshl_b32 s5, s74, 1
  s_add_u32 s7, s7, s5
  s_mul_i32 s4, s3, 229376
  s_lshl_b32 s5, s7, 8
  s_add_u32 s4, s4, s5
  v_mul_u32_u24 v10, 28672, v2
  v_lshl_add_u32 v10, v3, 4, v10
  v_add_u32 v10, s4, v10
  s_mov_b32 s6, 0
  buffer_load_dwordx4 v[16:19], v10, s[52:55], s6 offen nt
  s_add_u32 s6, s6, 3584
  buffer_load_dwordx4 v[20:23], v10, s[52:55], s6 offen nt
  s_add_u32 s6, s6, 3584
  buffer_load_dwordx4 v[24:27], v10, s[52:55], s6 offen nt
  s_add_u32 s6, s6, 3584
  buffer_load_dwordx4 v[28:31], v10, s[52:55], s6 offen nt
  s_add_u32 s6, s6, 3584
  buffer_load_dwordx4 v[32:35], v10, s[52:55], s6 offen nt
  s_add_u32 s6, s6, 3584
  buffer_load_dwordx4 v[36:39], v10, s[52:55], s6 offen nt
  s_add_u32 s6, s6, 3584
  buffer_load_dwordx4 v[40:43], v10, s[52:55], s6 offen nt
  s_add_u32 s6, s6, 3584
  buffer_load_dwordx4 v[44:47], v10, s[52:55], s6 offen nt
  s_add_u32 s6, s6, 89600
  buffer_load_dwordx4 v[48:51], v10, s[52:55], s6 offen nt
  s_add_u32 s6, s6, 3584
  buffer_load_dwordx4 v[52:55], v10, s[52:55], s6 offen nt
  s_add_u32 s6, s6, 3584
  buffer_load_dwordx4 v[56:59], v10, s[52:55], s6 offen nt
  s_add_u32 s6, s6, 3584
  buffer_load_dwordx4 v[60:63], v10, s[52:55], s6 offen nt
  s_add_u32 s6, s6, 3584
  buffer_load_dwordx4 v[64:67], v10, s[52:55], s6 offen nt
  s_add_u32 s6, s6, 3584
  buffer_load_dwordx4 v[68:71], v10, s[52:55], s6 offen nt
  s_add_u32 s6, s6, 3584
  buffer_load_dwordx4 v[72:75], v10, s[52:55], s6 offen nt
  s_add_u32 s6, s6, 3584
  buffer_load_dwordx4 v[76:79], v10, s[52:55], s6 offen nt
  s_mov_b32 s6, 0
  buffer_load_dwordx4 v[80:83], v10, s[56:59], s6 offen nt
  s_add_u32 s6, s6, 3584
  buffer_load_dwordx4 v[84:87], v10, s[56:59], s6 offen nt
  s_add_u32 s6, s6, 3584
  buffer_load_dwordx4 v[88:91], v10, s[56:59], s6 offen nt
  s_add_u32 s6, s6, 3584
  buffer_load_dwordx4 v[92:95], v10, s[56:59], s6 offen nt
  s_add_u32 s6, s6, 3584
  buffer_load_dwordx4 v[96:99], v10, s[56:59], s6 offen nt
  s_add_u32 s6, s6, 3584
  buffer_load_dwordx4 v[100:103], v10, s[56:59], s6 offen nt
  s_add_u32 s6, s6, 3584
  buffer_load_dwordx4 v[104:107], v10, s[56:59], s6 offen nt
  s_add_u32 s6, s6, 3584
  buffer_load_dwordx4 v[108:111], v10, s[56:59], s6 offen nt
  s_add_u32 s6, s6, 89600
  buffer_load_dwordx4 v[112:115], v10, s[56:59], s6 offen nt
  s_add_u32 s6, s6, 3584
  buffer_load_dwordx4 v[116:119], v10, s[56:59], s6 offen nt
  s_add_u32 s6, s6, 3584
  buffer_load_dwordx4 v[120:123], v10, s[56:59], s6 offen nt
  s_add_u32 s6, s6, 3584
  buffer_load_dwordx4 v[124:127], v10, s[56:59], s6 offen nt
  s_add_u32 s6, s6, 3584
  buffer_load_dwordx4 v[128:131], v10, s[56:59], s6 offen nt
  s_add_u32 s6, s6, 3584
  buffer_load_dwordx4 v[132:135], v10, s[56:59], s6 offen nt
  s_add_u32 s6, s6, 3584
  buffer_load_dwordx4 v[136:139], v10, s[56:59], s6 offen nt
  s_add_u32 s6, s6, 3584
  buffer_load_dwordx4 v[140:143], v10, s[56:59], s6 offen nt
  s_barrier
  s_waitcnt vmcnt(32)
  v_lshlrev_b32 v176, 16, v144
  v_and_b32 v177, 0xffff0000, v144
  v_lshlrev_b32 v178, 16, v145
  v_and_b32 v179, 0xffff0000, v145
  v_lshlrev_b32 v180, 16, v146
  v_and_b32 v181, 0xffff0000, v146
  v_lshlrev_b32 v182, 16, v147
  v_and_b32 v183, 0xffff0000, v147
  v_lshlrev_b32 v184, 16, v148
  v_and_b32 v185, 0xffff0000, v148
  v_lshlrev_b32 v186, 16, v149
  v_and_b32 v187, 0xffff0000, v149
  v_lshlrev_b32 v188, 16, v150
  v_and_b32 v189, 0xffff0000, v150
  v_lshlrev_b32 v190, 16, v151
  v_and_b32 v191, 0xffff0000, v151
  v_lshlrev_b32 v192, 16, v152
  v_and_b32 v193, 0xffff0000, v152
  v_lshlrev_b32 v194, 16, v153
  v_and_b32 v195, 0xffff0000, v153
  v_lshlrev_b32 v196, 16, v154
  v_and_b32 v197, 0xffff0000, v154
  v_lshlrev_b32 v198, 16, v155
  v_and_b32 v199, 0xffff0000, v155
  v_lshlrev_b32 v200, 16, v156
  v_and_b32 v201, 0xffff0000, v156
  v_lshlrev_b32 v202, 16, v157
  v_and_b32 v203, 0xffff0000, v157
  v_lshlrev_b32 v204, 16, v158
  v_and_b32 v205, 0xffff0000, v158
  v_lshlrev_b32 v206, 16, v159
  v_and_b32 v207, 0xffff0000, v159
  v_add_f32 v208, v176, v177
  v_mul_f32 v212, v176, v176
  v_add_f32 v209, v184, v185
  v_mul_f32 v213, v184, v184
  v_add_f32 v210, v192, v193
  v_mul_f32 v214, v192, v192
  v_add_f32 v211, v200, v201
  v_mul_f32 v215, v200, v200
  v_fmac_f32 v212, v177, v177
  v_fmac_f32 v213, v185, v185
  v_fmac_f32 v214, v193, v193
  v_fmac_f32 v215, v201, v201
  v_add_f32 v208, v208, v178
  v_fmac_f32 v212, v178, v178
  v_add_f32 v209, v209, v186
  v_fmac_f32 v213, v186, v186
  v_add_f32 v210, v210, v194
  v_fmac_f32 v214, v194, v194
  v_add_f32 v211, v211, v202
  v_fmac_f32 v215, v202, v202
  v_add_f32 v208, v208, v179
  v_fmac_f32 v212, v179, v179
  v_add_f32 v209, v209, v187
  v_fmac_f32 v213, v187, v187
  v_add_f32 v210, v210, v195
  v_fmac_f32 v214, v195, v195
  v_add_f32 v211, v211, v203
  v_fmac_f32 v215, v203, v203
  v_add_f32 v208, v208, v180
  v_fmac_f32 v212, v180, v180
  v_add_f32 v209, v209, v188
  v_fmac_f32 v213, v188, v188
  v_add_f32 v210, v210, v196
  v_fmac_f32 v214, v196, v196
  v_add_f32 v211, v211, v204
  v_fmac_f32 v215, v204, v204
  v_add_f32 v208, v208, v181
  v_fmac_f32 v212, v181, v181
  v_add_f32 v209, v209, v189
  v_fmac_f32 v213, v189, v189
  v_add_f32 v210, v210, v197
  v_fmac_f32 v214, v197, v197
  v_add_f32 v211, v211, v205
  v_fmac_f32 v215, v205, v205
  v_add_f32 v208, v208, v182
  v_fmac_f32 v212, v182, v182
  v_add_f32 v209, v209, v190
  v_fmac_f32 v213, v190, v190
  v_add_f32 v210, v210, v198
  v_fmac_f32 v214, v198, v198
  v_add_f32 v211, v211, v206
  v_fmac_f32 v215, v206, v206
  v_add_f32 v208, v208, v183
  v_fmac_f32 v212, v183, v183
  v_add_f32 v209, v209, v191
  v_fmac_f32 v213, v191, v191
  v_add_f32 v210, v210, v199
  v_fmac_f32 v214, v199, v199
  v_add_f32 v211, v211, v207
  v_fmac_f32 v215, v207, v207
  v_add_f32_dpp v208, v208, v208 row_shr:1 row_mask:0xf bank_mask:0xf bound_ctrl:0
  v_add_f32_dpp v209, v209, v209 row_shr:1 row_mask:0xf bank_mask:0xf bound_ctrl:0
  v_add_f32_dpp v210, v210, v210 row_shr:1 row_mask:0xf bank_mask:0xf bound_ctrl:0
  v_add_f32_dpp v211, v211, v211 row_shr:1 row_mask:0xf bank_mask:0xf bound_ctrl:0
  v_add_f32_dpp v212, v212, v212 row_shr:1 row_mask:0xf bank_mask:0xf bound_ctrl:0
  v_add_f32_dpp v213, v213, v213 row_shr:1 row_mask:0xf bank_mask:0xf bound_ctrl:0
  v_add_f32_dpp v214, v214, v214 row_shr:1 row_mask:0xf bank_mask:0xf bound_ctrl:0
  v_add_f32_dpp v215, v215, v215 row_shr:1 row_mask:0xf bank_mask:0xf bound_ctrl:0
  v_add_f32_dpp v208, v208, v208 row_shr:2 row_mask:0xf bank_mask:0xf bound_ctrl:0
  v_add_f32_dpp v209, v209, v209 row_shr:2 row_mask:0xf bank_mask:0xf bound_ctrl:0
  v_add_f32_dpp v210, v210, v210 row_shr:2 row_mask:0xf bank_mask:0xf bound_ctrl:0
  v_add_f32_dpp v211, v211, v211 row_shr:2 row_mask:0xf bank_mask:0xf bound_ctrl:0
  v_add_f32_dpp v212, v212, v212 row_shr:2 row_mask:0xf bank_mask:0xf bound_ctrl:0
  v_add_f32_dpp v213, v213, v213 row_shr:2 row_mask:0xf bank_mask:0xf bound_ctrl:0
  v_add_f32_dpp v214, v214, v214 row_shr:2 row_mask:0xf bank_mask:0xf bound_ctrl:0
  v_add_f32_dpp v215, v215, v215 row_shr:2 row_mask:0xf bank_mask:0xf bound_ctrl:0
  v_add_f32_dpp v208, v208, v208 row_shr:4 row_mask:0xf bank_mask:0xf bound_ctrl:0
  v_add_f32_dpp v209, v209, v209 row_shr:4 row_mask:0xf bank_mask:0xf bound_ctrl:0
  v_add_f32_dpp v210, v210, v210 row_shr:4 row_mask:0xf bank_mask:0xf bound_ctrl:0
  v_add_f32_dpp v211, v211, v211 row_shr:4 row_mask:0xf bank_mask:0xf bound_ctrl:0
  v_add_f32_dpp v212, v212, v212 row_shr:4 row_mask:0xf bank_mask:0xf bound_ctrl:0
  v_add_f32_dpp v213, v213, v213 row_shr:4 row_mask:0xf bank_mask:0xf bound_ctrl:0
  v_add_f32_dpp v214, v214, v214 row_shr:4 row_mask:0xf bank_mask:0xf bound_ctrl:0
  v_add_f32_dpp v215, v215, v215 row_shr:4 row_mask:0xf bank_mask:0xf bound_ctrl:0
  v_add_f32_dpp v208, v208, v208 row_shr:8 row_mask:0xf bank_mask:0xf bound_ctrl:0
  v_add_f32_dpp v209, v209, v209 row_shr:8 row_mask:0xf bank_mask:0xf bound_ctrl:0
  v_add_f32_dpp v210, v210, v210 row_shr:8 row_mask:0xf bank_mask:0xf bound_ctrl:0
  v_add_f32_dpp v211, v211, v211 row_shr:8 row_mask:0xf bank_mask:0xf bound_ctrl:0
  v_add_f32_dpp v212, v212, v212 row_shr:8 row_mask:0xf bank_mask:0xf bound_ctrl:0
  v_add_f32_dpp v213, v213, v213 row_shr:8 row_mask:0xf bank_mask:0xf bound_ctrl:0
  v_add_f32_dpp v214, v214, v214 row_shr:8 row_mask:0xf bank_mask:0xf bound_ctrl:0
  v_add_f32_dpp v215, v215, v215 row_shr:8 row_mask:0xf bank_mask:0xf bound_ctrl:0
  v_add_f32_dpp v208, v208, v208 row_bcast:15 row_mask:0xa bank_mask:0xf
  v_add_f32_dpp v209, v209, v209 row_bcast:15 row_mask:0xa bank_mask:0xf
  v_add_f32_dpp v210, v210, v210 row_bcast:15 row_mask:0xa bank_mask:0xf
  v_add_f32_dpp v211, v211, v211 row_bcast:15 row_mask:0xa bank_mask:0xf
  v_add_f32_dpp v212, v212, v212 row_bcast:15 row_mask:0xa bank_mask:0xf
  v_add_f32_dpp v213, v213, v213 row_bcast:15 row_mask:0xa bank_mask:0xf
  v_add_f32_dpp v214, v214, v214 row_bcast:15 row_mask:0xa bank_mask:0xf
  v_add_f32_dpp v215, v215, v215 row_bcast:15 row_mask:0xa bank_mask:0xf
  v_add_f32_dpp v208, v208, v208 row_bcast:31 row_mask:0xc bank_mask:0xf
  v_add_f32_dpp v209, v209, v209 row_bcast:31 row_mask:0xc bank_mask:0xf
  v_add_f32_dpp v210, v210, v210 row_bcast:31 row_mask:0xc bank_mask:0xf
  v_add_f32_dpp v211, v211, v211 row_bcast:31 row_mask:0xc bank_mask:0xf
  v_add_f32_dpp v212, v212, v212 row_bcast:31 row_mask:0xc bank_mask:0xf
  v_add_f32_dpp v213, v213, v213 row_bcast:31 row_mask:0xc bank_mask:0xf
  v_add_f32_dpp v214, v214, v214 row_bcast:31 row_mask:0xc bank_mask:0xf
  v_add_f32_dpp v215, v215, v215 row_bcast:31 row_mask:0xc bank_mask:0xf
  v_readlane_b32 s12, v208, 63
  v_readlane_b32 s13, v209, 63
  v_readlane_b32 s14, v210, 63
  v_readlane_b32 s15, v211, 63
  v_readlane_b32 s26, v212, 63
  v_readlane_b32 s27, v213, 63
  v_readlane_b32 s4, v214, 63
  v_readlane_b32 s5, v215, 63
  v_mov_b32 v224, 0x3b000000
  v_mul_f32 v216, s12, v224
  v_mul_f32 v220, s26, v224
  v_fma_f32 v220, -v216, v216, v220
  v_cvt_pk_bf16_f32 v216, v216, v220
  v_and_b32 v220, 0xffff0000, v216
  v_lshlrev_b32 v216, 16, v216
  v_add_f32 v220, 0x3727c5ac, v220
  v_cvt_pk_bf16_f32 v220, v220, v220
  v_lshlrev_b32 v220, 16, v220
  v_sqrt_f32 v220, v220
  s_nop 0
  v_cvt_pk_bf16_f32 v220, v220, v220
  v_lshlrev_b32 v220, 16, v220
  v_rcp_f32 v220, v220
  v_mov_b32 v225, 0x3b000000
  v_mul_f32 v217, s13, v225
  v_mul_f32 v221, s27, v225
  v_fma_f32 v221, -v217, v217, v221
  v_cvt_pk_bf16_f32 v217, v217, v221
  v_and_b32 v221, 0xffff0000, v217
  v_lshlrev_b32 v217, 16, v217
  v_add_f32 v221, 0x3727c5ac, v221
  v_cvt_pk_bf16_f32 v221, v221, v221
  v_lshlrev_b32 v221, 16, v221
  v_sqrt_f32 v221, v221
  s_nop 0
  v_cvt_pk_bf16_f32 v221, v221, v221
  v_lshlrev_b32 v221, 16, v221
  v_rcp_f32 v221, v221
  v_mov_b32 v226, 0x3b000000
  v_mul_f32 v218, s14, v226
  v_mul_f32 v222, s4, v226
  v_fma_f32 v222, -v218, v218, v222
  v_cvt_pk_bf16_f32 v218, v218, v222
  v_and_b32 v222, 0xffff0000, v218
  v_lshlrev_b32 v218, 16, v218
  v_add_f32 v222, 0x3727c5ac, v222
  v_cvt_pk_bf16_f32 v222, v222, v222
  v_lshlrev_b32 v222, 16, v222
  v_sqrt_f32 v222, v222
  s_nop 0
  v_cvt_pk_bf16_f32 v222, v222, v222
  v_lshlrev_b32 v222, 16, v222
  v_rcp_f32 v222, v222
  v_mov_b32 v227, 0x3b000000
  v_mul_f32 v219, s15, v227
  v_mul_f32 v223, s5, v227
  v_fma_f32 v223, -v219, v219, v223
  v_cvt_pk_bf16_f32 v219, v219, v223
  v_and_b32 v223, 0xffff0000, v219
  v_lshlrev_b32 v219, 16, v219
  v_add_f32 v223, 0x3727c5ac, v223
  v_cvt_pk_bf16_f32 v223, v223, v223
  v_lshlrev_b32 v223, 16, v223
  v_sqrt_f32 v223, v223
  s_nop 0
  v_cvt_pk_bf16_f32 v223, v223, v223
  v_lshlrev_b32 v223, 16, v223
  v_rcp_f32 v223, v223
  v_sub_f32 v176, v176, v216
  v_sub_f32 v177, v177, v216
  v_cvt_pk_bf16_f32 v177, v176, v177
  v_lshlrev_b32 v176, 16, v177
  v_and_b32 v177, 0xffff0000, v177
  v_mul_f32 v176, v176, v220
  v_mul_f32 v177, v177, v220
  v_cvt_pk_bf16_f32 v144, v176, v177
  v_sub_f32 v178, v178, v216
  v_sub_f32 v179, v179, v216
  v_cvt_pk_bf16_f32 v179, v178, v179
  v_lshlrev_b32 v178, 16, v179
  v_and_b32 v179, 0xffff0000, v179
  v_mul_f32 v178, v178, v220
  v_mul_f32 v179, v179, v220
  v_cvt_pk_bf16_f32 v145, v178, v179
  v_sub_f32 v180, v180, v216
  v_sub_f32 v181, v181, v216
  v_cvt_pk_bf16_f32 v181, v180, v181
  v_lshlrev_b32 v180, 16, v181
  v_and_b32 v181, 0xffff0000, v181
  v_mul_f32 v180, v180, v220
  v_mul_f32 v181, v181, v220
  v_cvt_pk_bf16_f32 v146, v180, v181
  v_sub_f32 v182, v182, v216
  v_sub_f32 v183, v183, v216
  v_cvt_pk_bf16_f32 v183, v182, v183
  v_lshlrev_b32 v182, 16, v183
  v_and_b32 v183, 0xffff0000, v183
  v_mul_f32 v182, v182, v220
  v_mul_f32 v183, v183, v220
  v_cvt_pk_bf16_f32 v147, v182, v183
  v_sub_f32 v184, v184, v217
  v_sub_f32 v185, v185, v217
  v_cvt_pk_bf16_f32 v185, v184, v185
  v_lshlrev_b32 v184, 16, v185
  v_and_b32 v185, 0xffff0000, v185
  v_mul_f32 v184, v184, v221
  v_mul_f32 v185, v185, v221
  v_cvt_pk_bf16_f32 v148, v184, v185
  v_sub_f32 v186, v186, v217
  v_sub_f32 v187, v187, v217
  v_cvt_pk_bf16_f32 v187, v186, v187
  v_lshlrev_b32 v186, 16, v187
  v_and_b32 v187, 0xffff0000, v187
  v_mul_f32 v186, v186, v221
  v_mul_f32 v187, v187, v221
  v_cvt_pk_bf16_f32 v149, v186, v187
  v_sub_f32 v188, v188, v217
  v_sub_f32 v189, v189, v217
  v_cvt_pk_bf16_f32 v189, v188, v189
  v_lshlrev_b32 v188, 16, v189
  v_and_b32 v189, 0xffff0000, v189
  v_mul_f32 v188, v188, v221
  v_mul_f32 v189, v189, v221
  v_cvt_pk_bf16_f32 v150, v188, v189
  v_sub_f32 v190, v190, v217
  v_sub_f32 v191, v191, v217
  v_cvt_pk_bf16_f32 v191, v190, v191
  v_lshlrev_b32 v190, 16, v191
  v_and_b32 v191, 0xffff0000, v191
  v_mul_f32 v190, v190, v221
  v_mul_f32 v191, v191, v221
  v_cvt_pk_bf16_f32 v151, v190, v191
  v_sub_f32 v192, v192, v218
  v_sub_f32 v193, v193, v218
  v_cvt_pk_bf16_f32 v193, v192, v193
  v_lshlrev_b32 v192, 16, v193
  v_and_b32 v193, 0xffff0000, v193
  v_mul_f32 v192, v192, v222
  v_mul_f32 v193, v193, v222
  v_cvt_pk_bf16_f32 v152, v192, v193
  v_sub_f32 v194, v194, v218
  v_sub_f32 v195, v195, v218
  v_cvt_pk_bf16_f32 v195, v194, v195
  v_lshlrev_b32 v194, 16, v195
  v_and_b32 v195, 0xffff0000, v195
  v_mul_f32 v194, v194, v222
  v_mul_f32 v195, v195, v222
  v_cvt_pk_bf16_f32 v153, v194, v195
  v_sub_f32 v196, v196, v218
  v_sub_f32 v197, v197, v218
  v_cvt_pk_bf16_f32 v197, v196, v197
  v_lshlrev_b32 v196, 16, v197
  v_and_b32 v197, 0xffff0000, v197
  v_mul_f32 v196, v196, v222
  v_mul_f32 v197, v197, v222
  v_cvt_pk_bf16_f32 v154, v196, v197
  v_sub_f32 v198, v198, v218
  v_sub_f32 v199, v199, v218
  v_cvt_pk_bf16_f32 v199, v198, v199
  v_lshlrev_b32 v198, 16, v199
  v_and_b32 v199, 0xffff0000, v199
  v_mul_f32 v198, v198, v222
  v_mul_f32 v199, v199, v222
  v_cvt_pk_bf16_f32 v155, v198, v199
  v_sub_f32 v200, v200, v219
  v_sub_f32 v201, v201, v219
  v_cvt_pk_bf16_f32 v201, v200, v201
  v_lshlrev_b32 v200, 16, v201
  v_and_b32 v201, 0xffff0000, v201
  v_mul_f32 v200, v200, v223
  v_mul_f32 v201, v201, v223
  v_cvt_pk_bf16_f32 v156, v200, v201
  v_sub_f32 v202, v202, v219
  v_sub_f32 v203, v203, v219
  v_cvt_pk_bf16_f32 v203, v202, v203
  v_lshlrev_b32 v202, 16, v203
  v_and_b32 v203, 0xffff0000, v203
  v_mul_f32 v202, v202, v223
  v_mul_f32 v203, v203, v223
  v_cvt_pk_bf16_f32 v157, v202, v203
  v_sub_f32 v204, v204, v219
  v_sub_f32 v205, v205, v219
  v_cvt_pk_bf16_f32 v205, v204, v205
  v_lshlrev_b32 v204, 16, v205
  v_and_b32 v205, 0xffff0000, v205
  v_mul_f32 v204, v204, v223
  v_mul_f32 v205, v205, v223
  v_cvt_pk_bf16_f32 v158, v204, v205
  v_sub_f32 v206, v206, v219
  v_sub_f32 v207, v207, v219
  v_cvt_pk_bf16_f32 v207, v206, v207
  v_lshlrev_b32 v206, 16, v207
  v_and_b32 v207, 0xffff0000, v207
  v_mul_f32 v206, v206, v223
  v_mul_f32 v207, v207, v223
  v_cvt_pk_bf16_f32 v159, v206, v207
  v_lshlrev_b32 v9, 4, v1
  ds_write_b128 v9, v[144:147] offset:1408
  ds_write_b128 v9, v[148:151] offset:2496
  ds_write_b128 v9, v[152:155] offset:3584
  ds_write_b128 v9, v[156:159] offset:4672
  s_lshl_b32 s4, s3, 7
  v_and_b32 v9, 3, v3
  v_mul_u32_u24 v9, 1088, v9
  v_lshl_add_u32 v9, v2, 4, v9
  v_add_u32 v9, s4, v9
  s_waitcnt lgkmcnt(0)
  ds_read_b128 v[240:243], v9 offset:1408
  ds_read_b128 v[244:247], v9 offset:1472
  s_mov_b32 s80, 0x05040100
  s_mov_b32 s81, 0x07060302
  s_mov_b32 s12, 0x00f000f0
  s_mov_b32 s13, 0x00f000f0
  s_mov_b32 s14, 0x0f000f00
  s_mov_b32 s15, 0x0f000f00
  s_mov_b32 s26, 0xf000f000
  s_mov_b32 s27, 0xf000f000
  s_waitcnt vmcnt(24)
  v_perm_b32 v144, v20, v16, s80
  v_perm_b32 v148, v20, v16, s81
  v_perm_b32 v152, v21, v17, s80
  v_perm_b32 v156, v21, v17, s81
  v_perm_b32 v160, v22, v18, s80
  v_perm_b32 v164, v22, v18, s81
  v_perm_b32 v168, v23, v19, s80
  v_perm_b32 v172, v23, v19, s81
  v_perm_b32 v145, v28, v24, s80
  v_perm_b32 v149, v28, v24, s81
  v_perm_b32 v153, v29, v25, s80
  v_perm_b32 v157, v29, v25, s81
  v_perm_b32 v161, v30, v26, s80
  v_perm_b32 v165, v30, v26, s81
  v_perm_b32 v169, v31, v27, s80
  v_perm_b32 v173, v31, v27, s81
  v_perm_b32 v146, v36, v32, s80
  v_perm_b32 v150, v36, v32, s81
  v_perm_b32 v154, v37, v33, s80
  v_perm_b32 v158, v37, v33, s81
  v_perm_b32 v162, v38, v34, s80
  v_perm_b32 v166, v38, v34, s81
  v_perm_b32 v170, v39, v35, s80
  v_perm_b32 v174, v39, v35, s81
  v_perm_b32 v147, v44, v40, s80
  v_perm_b32 v151, v44, v40, s81
  v_perm_b32 v155, v45, v41, s80
  v_perm_b32 v159, v45, v41, s81
  v_perm_b32 v163, v46, v42, s80
  v_perm_b32 v167, v46, v42, s81
  v_perm_b32 v171, v47, v43, s80
  v_perm_b32 v175, v47, v43, s81
  s_waitcnt lgkmcnt(0)
  v_mfma_f32_16x16x32_bf16 v[176:179], v[144:147], v[240:243], 0
  v_mfma_f32_16x16x32_bf16 v[180:183], v[148:151], v[240:243], 0
  v_mfma_f32_16x16x32_bf16 v[184:187], v[152:155], v[240:243], 0
  v_mfma_f32_16x16x32_bf16 v[188:191], v[156:159], v[240:243], 0
  v_mfma_f32_16x16x32_bf16 v[192:195], v[160:163], v[240:243], 0
  v_mfma_f32_16x16x32_bf16 v[196:199], v[164:167], v[240:243], 0
  v_mfma_f32_16x16x32_bf16 v[200:203], v[168:171], v[240:243], 0
  v_mfma_f32_16x16x32_bf16 v[204:207], v[172:175], v[240:243], 0
  s_waitcnt vmcnt(16)
  v_perm_b32 v144, v52, v48, s80
  v_perm_b32 v148, v52, v48, s81
  v_perm_b32 v152, v53, v49, s80
  v_perm_b32 v156, v53, v49, s81
  v_perm_b32 v160, v54, v50, s80
  v_perm_b32 v164, v54, v50, s81
  v_perm_b32 v168, v55, v51, s80
  v_perm_b32 v172, v55, v51, s81
  v_perm_b32 v145, v60, v56, s80
  v_perm_b32 v149, v60, v56, s81
  v_perm_b32 v153, v61, v57, s80
  v_perm_b32 v157, v61, v57, s81
  v_perm_b32 v161, v62, v58, s80
  v_perm_b32 v165, v62, v58, s81
  v_perm_b32 v169, v63, v59, s80
  v_perm_b32 v173, v63, v59, s81
  v_perm_b32 v146, v68, v64, s80
  v_perm_b32 v150, v68, v64, s81
  v_perm_b32 v154, v69, v65, s80
  v_perm_b32 v158, v69, v65, s81
  v_perm_b32 v162, v70, v66, s80
  v_perm_b32 v166, v70, v66, s81
  v_perm_b32 v170, v71, v67, s80
  v_perm_b32 v174, v71, v67, s81
  v_perm_b32 v147, v76, v72, s80
  v_perm_b32 v151, v76, v72, s81
  v_perm_b32 v155, v77, v73, s80
  v_perm_b32 v159, v77, v73, s81
  v_perm_b32 v163, v78, v74, s80
  v_perm_b32 v167, v78, v74, s81
  v_perm_b32 v171, v79, v75, s80
  v_perm_b32 v175, v79, v75, s81
  v_mfma_f32_16x16x32_bf16 v[176:179], v[144:147], v[244:247], v[176:179]
  v_mfma_f32_16x16x32_bf16 v[180:183], v[148:151], v[244:247], v[180:183]
  v_mfma_f32_16x16x32_bf16 v[184:187], v[152:155], v[244:247], v[184:187]
  v_mfma_f32_16x16x32_bf16 v[188:191], v[156:159], v[244:247], v[188:191]
  v_mfma_f32_16x16x32_bf16 v[192:195], v[160:163], v[244:247], v[192:195]
  v_mfma_f32_16x16x32_bf16 v[196:199], v[164:167], v[244:247], v[196:199]
  v_mfma_f32_16x16x32_bf16 v[200:203], v[168:171], v[244:247], v[200:203]
  v_mfma_f32_16x16x32_bf16 v[204:207], v[172:175], v[244:247], v[204:207]
  s_waitcnt vmcnt(8)
  v_perm_b32 v144, v84, v80, s80
  v_perm_b32 v148, v84, v80, s81
  v_perm_b32 v152, v85, v81, s80
  v_perm_b32 v156, v85, v81, s81
  v_perm_b32 v160, v86, v82, s80
  v_perm_b32 v164, v86, v82, s81
  v_perm_b32 v168, v87, v83, s80
  v_perm_b32 v172, v87, v83, s81
  v_perm_b32 v145, v92, v88, s80
  v_perm_b32 v149, v92, v88, s81
  v_perm_b32 v153, v93, v89, s80
  v_perm_b32 v157, v93, v89, s81
  v_perm_b32 v161, v94, v90, s80
  v_perm_b32 v165, v94, v90, s81
  v_perm_b32 v169, v95, v91, s80
  v_perm_b32 v173, v95, v91, s81
  v_perm_b32 v146, v100, v96, s80
  v_perm_b32 v150, v100, v96, s81
  v_perm_b32 v154, v101, v97, s80
  v_perm_b32 v158, v101, v97, s81
  v_perm_b32 v162, v102, v98, s80
  v_perm_b32 v166, v102, v98, s81
  v_perm_b32 v170, v103, v99, s80
  v_perm_b32 v174, v103, v99, s81
  v_perm_b32 v147, v108, v104, s80
  v_perm_b32 v151, v108, v104, s81
  v_perm_b32 v155, v109, v105, s80
  v_perm_b32 v159, v109, v105, s81
  v_perm_b32 v163, v110, v106, s80
  v_perm_b32 v167, v110, v106, s81
  v_perm_b32 v171, v111, v107, s80
  v_perm_b32 v175, v111, v107, s81
  v_mfma_f32_16x16x32_bf16 v[208:211], v[144:147], v[240:243], 0
  v_mfma_f32_16x16x32_bf16 v[212:215], v[148:151], v[240:243], 0
  v_mfma_f32_16x16x32_bf16 v[216:219], v[152:155], v[240:243], 0
  v_mfma_f32_16x16x32_bf16 v[220:223], v[156:159], v[240:243], 0
  v_mfma_f32_16x16x32_bf16 v[224:227], v[160:163], v[240:243], 0
  v_mfma_f32_16x16x32_bf16 v[228:231], v[164:167], v[240:243], 0
  v_mfma_f32_16x16x32_bf16 v[232:235], v[168:171], v[240:243], 0
  v_mfma_f32_16x16x32_bf16 v[236:239], v[172:175], v[240:243], 0
  s_waitcnt vmcnt(0)
  v_perm_b32 v144, v116, v112, s80
  v_perm_b32 v148, v116, v112, s81
  v_perm_b32 v152, v117, v113, s80
  v_perm_b32 v156, v117, v113, s81
  v_perm_b32 v160, v118, v114, s80
  v_perm_b32 v164, v118, v114, s81
  v_perm_b32 v168, v119, v115, s80
  v_perm_b32 v172, v119, v115, s81
  v_perm_b32 v145, v124, v120, s80
  v_perm_b32 v149, v124, v120, s81
  v_perm_b32 v153, v125, v121, s80
  v_perm_b32 v157, v125, v121, s81
  v_perm_b32 v161, v126, v122, s80
  v_perm_b32 v165, v126, v122, s81
  v_perm_b32 v169, v127, v123, s80
  v_perm_b32 v173, v127, v123, s81
  v_perm_b32 v146, v132, v128, s80
  v_perm_b32 v150, v132, v128, s81
  v_perm_b32 v154, v133, v129, s80
  v_perm_b32 v158, v133, v129, s81
  v_perm_b32 v162, v134, v130, s80
  v_perm_b32 v166, v134, v130, s81
  v_perm_b32 v170, v135, v131, s80
  v_perm_b32 v174, v135, v131, s81
  v_perm_b32 v147, v140, v136, s80
  v_perm_b32 v151, v140, v136, s81
  v_perm_b32 v155, v141, v137, s80
  v_perm_b32 v159, v141, v137, s81
  v_perm_b32 v163, v142, v138, s80
  v_perm_b32 v167, v142, v138, s81
  v_perm_b32 v171, v143, v139, s80
  v_perm_b32 v175, v143, v139, s81
  v_mfma_f32_16x16x32_bf16 v[208:211], v[144:147], v[244:247], v[208:211]
  v_mfma_f32_16x16x32_bf16 v[212:215], v[148:151], v[244:247], v[212:215]
  v_mfma_f32_16x16x32_bf16 v[216:219], v[152:155], v[244:247], v[216:219]
  v_mfma_f32_16x16x32_bf16 v[220:223], v[156:159], v[244:247], v[220:223]
  v_mfma_f32_16x16x32_bf16 v[224:227], v[160:163], v[244:247], v[224:227]
  v_mfma_f32_16x16x32_bf16 v[228:231], v[164:167], v[244:247], v[228:231]
  v_mfma_f32_16x16x32_bf16 v[232:235], v[168:171], v[244:247], v[232:235]
  v_mfma_f32_16x16x32_bf16 v[236:239], v[172:175], v[244:247], v[236:239]
  s_waitcnt lgkmcnt(0)
  s_add_u32 s72, s72, 0x00100401
  s_add_u32 s73, s73, 1
  s_and_b32 s68, s72, 0x3ff
  s_bfe_u32 s69, s72, 0xa000a
  s_bfe_u32 s70, s72, 0xa0014
  s_and_b32 s71, s73, 0x3ff
  s_lshl_b32 s4, s7, 15
  s_lshl_b32 s5, s3, 9
  s_add_u32 s4, s4, s5
  s_add_u32 s4, s4, 589824
  v_and_b32 v9, 3, v3
  v_lshlrev_b32 v9, 7, v9
  v_lshrrev_b32 v10, 2, v3
  v_lshl_add_u32 v9, v10, 13, v9
  v_lshl_add_u32 v9, v2, 4, v9
  v_add_u32 v11, s4, v9
  v_cndmask_b32 v144, v176, v177, s[12:13]
  v_cndmask_b32 v145, v180, v181, s[12:13]
  v_cndmask_b32 v146, v184, v185, s[12:13]
  v_cndmask_b32 v147, v188, v189, s[12:13]
  v_cndmask_b32 v148, v192, v193, s[12:13]
  v_cndmask_b32 v149, v196, v197, s[12:13]
  v_cndmask_b32 v150, v200, v201, s[12:13]
  v_cndmask_b32 v151, v204, v205, s[12:13]
  v_cndmask_b32 v144, v144, v178, s[14:15]
  v_cndmask_b32 v145, v145, v182, s[14:15]
  v_cndmask_b32 v146, v146, v186, s[14:15]
  v_cndmask_b32 v147, v147, v190, s[14:15]
  v_cndmask_b32 v148, v148, v194, s[14:15]
  v_cndmask_b32 v149, v149, v198, s[14:15]
  v_cndmask_b32 v150, v150, v202, s[14:15]
  v_cndmask_b32 v151, v151, v206, s[14:15]
  v_cndmask_b32 v144, v144, v179, s[26:27]
  v_cndmask_b32 v145, v145, v183, s[26:27]
  v_cndmask_b32 v146, v146, v187, s[26:27]
  v_cndmask_b32 v147, v147, v191, s[26:27]
  v_cndmask_b32 v148, v148, v195, s[26:27]
  v_cndmask_b32 v149, v149, v199, s[26:27]
  v_cndmask_b32 v150, v150, v203, s[26:27]
  v_cndmask_b32 v151, v151, v207, s[26:27]
  v_bfi_b32 v144, v8, s68, v144
  v_bfi_b32 v145, v8, s69, v145
  v_bfi_b32 v146, v8, s70, v146
  v_bfi_b32 v147, v8, s71, v147
  v_bfi_b32 v148, v8, s68, v148
  v_bfi_b32 v149, v8, s69, v149
  v_bfi_b32 v150, v8, s70, v150
  v_bfi_b32 v151, v8, s71, v151
  v_cndmask_b32 v152, v208, v209, s[12:13]
  v_cndmask_b32 v153, v212, v213, s[12:13]
  v_cndmask_b32 v154, v216, v217, s[12:13]
  v_cndmask_b32 v155, v220, v221, s[12:13]
  v_cndmask_b32 v156, v224, v225, s[12:13]
  v_cndmask_b32 v157, v228, v229, s[12:13]
  v_cndmask_b32 v158, v232, v233, s[12:13]
  v_cndmask_b32 v159, v236, v237, s[12:13]
  v_cndmask_b32 v152, v152, v210, s[14:15]
  v_cndmask_b32 v153, v153, v214, s[14:15]
  v_cndmask_b32 v154, v154, v218, s[14:15]
  v_cndmask_b32 v155, v155, v222, s[14:15]
  v_cndmask_b32 v156, v156, v226, s[14:15]
  v_cndmask_b32 v157, v157, v230, s[14:15]
  v_cndmask_b32 v158, v158, v234, s[14:15]
  v_cndmask_b32 v159, v159, v238, s[14:15]
  v_cndmask_b32 v152, v152, v211, s[26:27]
  v_cndmask_b32 v153, v153, v215, s[26:27]
  v_cndmask_b32 v154, v154, v219, s[26:27]
  v_cndmask_b32 v155, v155, v223, s[26:27]
  v_cndmask_b32 v156, v156, v227, s[26:27]
  v_cndmask_b32 v157, v157, v231, s[26:27]
  v_cndmask_b32 v158, v158, v235, s[26:27]
  v_cndmask_b32 v159, v159, v239, s[26:27]
  v_bfi_b32 v152, v8, s68, v152
  v_bfi_b32 v153, v8, s69, v153
  v_bfi_b32 v154, v8, s70, v154
  v_bfi_b32 v155, v8, s71, v155
  v_bfi_b32 v156, v8, s68, v156
  v_bfi_b32 v157, v8, s69, v157
  v_bfi_b32 v158, v8, s70, v158
  v_bfi_b32 v159, v8, s71, v159
  s_mov_b32 s3, 64
  s_mov_b32 s7, 2
  s_branch L_w0_pub
L_w0_none:
  s_barrier
  s_waitcnt lgkmcnt(0)
  s_add_u32 s72, s72, 0x00100401
  s_add_u32 s73, s73, 1
  s_and_b32 s68, s72, 0x3ff
  s_bfe_u32 s69, s72, 0xa000a
  s_bfe_u32 s70, s72, 0xa0014
  s_and_b32 s71, s73, 0x3ff
  s_mov_b32 s7, 0
  s_mov_b32 s3, 0
  v_mov_b32 v11, 0
L_w0_pub:
  s_getreg_b32 s79, hwreg(HW_REG_XCC_ID, 0, 4)
  s_lshl_b32 s79, s79, 16
  s_or_b32 s5, s79, s68
  v_mov_b32 v12, s5
  v_mov_b32 v13, s69
  v_mov_b32 v14, s70
  v_mov_b32 v15, s71
  s_lshl_b32 s5, s74, 9
  s_lshl_b32 s6, s75, 4
  s_add_u32 s5, s5, s6
  s_add_u32 s5, s5, 32768
  v_mov_b32 v10, s5
  s_mov_b32 s82, 0
  s_mov_b32 s4, 0
  s_cmp_eq_u32 s7, 0
  s_cbranch_scc1 L_p2_2
  s_add_u32 s5, s4, s3
  buffer_store_dwordx4 v[144:147], v11, s[48:51], s4 offen
  buffer_store_dwordx4 v[148:151], v11, s[48:51], s5 offen
  s_cmp_eq_u32 s7, 1
  s_cbranch_scc1 L_p2_2
  s_add_u32 s6, s4, 4096
  s_add_u32 s5, s5, 4096
  buffer_store_dwordx4 v[152:155], v11, s[48:51], s6 offen
  buffer_store_dwordx4 v[156:159], v11, s[48:51], s5 offen
L_p2_2:
  s_mov_b64 exec, 1
  buffer_store_dwordx4 v[12:15], v10, s[48:51], s4 offen
  s_mov_b64 exec, -1
  v_mov_b32 v238, 0
  v_mov_b32 v239, 3
  s_mov_b64 exec, 1
  ds_add_u32 v238, v239 offset:8
  s_mov_b64 exec, -1
  v_and_b32 v9, 31, v1
  v_lshlrev_b32 v9, 4, v9
  s_lshl_b32 s5, s74, 9
  s_add_u32 s5, s5, 32768
  v_add_u32 v9, s5, v9
  v_mov_b32 v253, s79
  s_mov_b32 s83, 0
  s_mov_b32 s4, 0
  buffer_load_dwordx4 v[248:251], v9, s[48:51], s4 offen sc1
  s_mov_b32 s5, 3145728
  s_mov_b64 exec, 1
  buffer_store_dwordx4 v[12:15], v10, s[48:51], s5 offen sc1
  s_mov_b64 exec, -1
  s_waitcnt vmcnt(1)
  s_branch L_xchk_4
L_xpre_3:
  s_and_b32 s5, s83, 3
  s_cmp_eq_u32 s5, 3
  s_cselect_b32 s4, 3145728, 0
  buffer_load_dwordx4 v[248:251], v9, s[48:51], s4 offen sc1
  s_waitcnt vmcnt(0)
L_xchk_4:
  v_and_b32 v252, 0xf0000, v248
  v_xor_b32 v248, v252, v248
  v_xor_b32 v248, s68, v248
  v_xor_b32 v249, s69, v249
  v_xor_b32 v250, s70, v250
  v_xor_b32 v251, s71, v251
  v_or3_b32 v176, v248, v249, v250
  v_or_b32 v176, v176, v251
  v_and_b32 v176, v8, v176
  v_cmp_ne_u32 vcc, 0, v176
  s_cbranch_vccz L_xok_5
  s_add_u32 s83, s83, 1
  s_cmp_lt_u32 s83, 200000
  s_cbranch_scc1 L_xpre_3
L_xok_5:
  v_cmp_ne_u32 vcc, v253, v252
  s_mov_b32 s79, 1
  s_cbranch_vccz L_mode_ok
  s_mov_b32 s79, 0
L_mode_ok:
  s_cmp_eq_u32 s79, 1
  s_cbranch_scc1 L_mode_loc
  s_cmp_eq_u32 s82, 0
  s_cbranch_scc0 L_nb_6
  s_mov_b32 s82, 3145728
  s_cmp_eq_u32 s7, 0
  s_cbranch_scc1 L_p2_8
  s_add_u32 s5, s82, s3
  buffer_store_dwordx4 v[144:147], v11, s[48:51], s82 offen sc1
  buffer_store_dwordx4 v[148:151], v11, s[48:51], s5 offen sc1
  s_cmp_eq_u32 s7, 1
  s_cbranch_scc1 L_p2_8
  s_add_u32 s6, s82, 4096
  s_add_u32 s5, s5, 4096
  buffer_store_dwordx4 v[152:155], v11, s[48:51], s6 offen sc1
  buffer_store_dwordx4 v[156:159], v11, s[48:51], s5 offen sc1
L_p2_8:
  s_mov_b64 exec, 1
  buffer_store_dwordx4 v[12:15], v10, s[48:51], s82 offen sc1
  s_mov_b64 exec, -1
L_nb_6:
L_mode_loc:
  v_mov_b32 v9, 0
  v_mov_b32 v10, s79
  ds_write_b32 v9, v10 offset:4
  s_waitcnt lgkmcnt(0)
  v_mov_b32 v10, 1
  ds_write_b32 v9, v10 offset:12
  s_lshl_b32 s4, s74, 15
  s_lshl_b32 s5, s76, 13
  s_add_u32 s4, s4, s5
  s_add_u32 s4, s4, 65536
  s_cmp_eq_u32 s79, 1
  s_cselect_b32 s5, 0, 3145728
  s_add_u32 s4, s4, s5
  v_lshlrev_b32 v9, 4, v1
  v_add_u32 v9, s4, v9
  s_mov_b32 s83, 0
L_qfull_9:
  buffer_load_dwordx4 v[184:187], v9, s[48:51], 0 offen offset:0 sc1
  buffer_load_dwordx4 v[188:191], v9, s[48:51], 0 offen offset:1024 sc1
  buffer_load_dwordx4 v[192:195], v9, s[48:51], 0 offen offset:2048 sc1
  buffer_load_dwordx4 v[196:199], v9, s[48:51], 0 offen offset:3072 sc1
  buffer_load_dwordx4 v[200:203], v9, s[48:51], s9 offen offset:0 sc1
  buffer_load_dwordx4 v[204:207], v9, s[48:51], s9 offen offset:1024 sc1
  buffer_load_dwordx4 v[208:211], v9, s[48:51], s9 offen offset:2048 sc1
  buffer_load_dwordx4 v[212:215], v9, s[48:51], s9 offen offset:3072 sc1
  s_waitcnt vmcnt(0)
  v_xor_b32 v184, s68, v184
  v_xor_b32 v185, s69, v185
  v_xor_b32 v186, s70, v186
  v_xor_b32 v187, s71, v187
  v_xor_b32 v188, s68, v188
  v_xor_b32 v189, s69, v189
  v_xor_b32 v190, s70, v190
  v_xor_b32 v191, s71, v191
  v_xor_b32 v192, s68, v192
  v_xor_b32 v193, s69, v193
  v_xor_b32 v194, s70, v194
  v_xor_b32 v195, s71, v195
  v_xor_b32 v196, s68, v196
  v_xor_b32 v197, s69, v197
  v_xor_b32 v198, s70, v198
  v_xor_b32 v199, s71, v199
  v_xor_b32 v200, s68, v200
  v_xor_b32 v201, s69, v201
  v_xor_b32 v202, s70, v202
  v_xor_b32 v203, s71, v203
  v_xor_b32 v204, s68, v204
  v_xor_b32 v205, s69, v205
  v_xor_b32 v206, s70, v206
  v_xor_b32 v207, s71, v207
  v_xor_b32 v208, s68, v208
  v_xor_b32 v209, s69, v209
  v_xor_b32 v210, s70, v210
  v_xor_b32 v211, s71, v211
  v_xor_b32 v212, s68, v212
  v_xor_b32 v213, s69, v213
  v_xor_b32 v214, s70, v214
  v_xor_b32 v215, s71, v215
  v_or3_b32 v10, v184, v185, v186
  v_or3_b32 v10, v10, v187, v188
  v_or3_b32 v10, v10, v189, v190
  v_or3_b32 v10, v10, v191, v192
  v_or3_b32 v10, v10, v193, v194
  v_or3_b32 v10, v10, v195, v196
  v_or3_b32 v10, v10, v197, v198
  v_or3_b32 v10, v10, v199, v200
  v_or3_b32 v10, v10, v201, v202
  v_or3_b32 v10, v10, v203, v204
  v_or3_b32 v10, v10, v205, v206
  v_or3_b32 v10, v10, v207, v208
  v_or3_b32 v10, v10, v209, v210
  v_or3_b32 v10, v10, v211, v212
  v_or3_b32 v10, v10, v213, v214
  v_or_b32 v10, v10, v215
  v_and_b32 v10, v8, v10
  v_cmp_ne_u32 vcc, 0, v10
  s_cbranch_vccz L_ok_10
  s_add_u32 s83, s83, 1
  s_cmp_lt_u32 s83, 200000
  s_cbranch_scc0 L_ok_10
  s_branch L_qfull_9
L_ok_10:
  v_add_f32 v184, v184, v192
  v_add_f32 v185, v185, v193
  v_add_f32 v186, v186, v194
  v_add_f32 v187, v187, v195
  v_add_f32 v188, v188, v196
  v_add_f32 v189, v189, v197
  v_add_f32 v190, v190, v198
  v_add_f32 v191, v191, v199
  v_add_f32 v184, v184, v200
  v_add_f32 v185, v185, v201
  v_add_f32 v186, v186, v202
  v_add_f32 v187, v187, v203
  v_add_f32 v188, v188, v204
  v_add_f32 v189, v189, v205
  v_add_f32 v190, v190, v206
  v_add_f32 v191, v191, v207
  v_add_f32 v184, v184, v208
  v_add_f32 v185, v185, v209
  v_add_f32 v186, v186, v210
  v_add_f32 v187, v187, v211
  v_add_f32 v188, v188, v212
  v_add_f32 v189, v189, v213
  v_add_f32 v190, v190, v214
  v_add_f32 v191, v191, v215
  v_cvt_pk_bf16_f32 v184, v184, v185
  v_cvt_pk_bf16_f32 v185, v186, v187
  v_cvt_pk_bf16_f32 v186, v188, v189
  v_cvt_pk_bf16_f32 v187, v190, v191
  v_lshrrev_b32 v9, 5, v1
  v_mul_u32_u24 v9, 320, v9
  v_and_b32 v10, 3, v1
  v_lshl_add_u32 v9, v10, 6, v9
  v_bfe_u32 v10, v1, 2, 2
  v_lshl_add_u32 v9, v10, 4, v9
  v_bfe_u32 v10, v1, 4, 1
  v_lshl_add_u32 v9, v10, 3, v9
  ds_write_b64 v9, v[184:185] offset:64
  ds_write_b64 v9, v[186:187] offset:704
  v_mov_b32 v9, 0
  s_waitcnt lgkmcnt(0)
  v_mov_b32 v10, 1
  ds_write_b32 v9, v10 offset:0
  s_branch L_stream
L_w1_pre:
  s_barrier
  s_waitcnt lgkmcnt(0)
  s_add_u32 s72, s72, 0x00100401
  s_add_u32 s73, s73, 1
  s_and_b32 s68, s72, 0x3ff
  s_bfe_u32 s69, s72, 0xa000a
  s_bfe_u32 s70, s72, 0xa0014
  s_and_b32 s71, s73, 0x3ff
  v_bfe_u32 v9, v1, 3, 2
  v_mul_u32_u24 v11, 80, v9
  v_and_b32 v10, 7, v1
  v_lshl_add_u32 v11, v10, 3, v11
  s_cmp_ge_u32 s74, 7
  s_cbranch_scc1 L_h_zero
  s_and_b32 s4, s75, 3
  s_lshl_b32 s5, s74, 2
  s_add_u32 s4, s4, s5
  s_lshl_b32 s7, s4, 1
  s_bfe_u32 s5, s75, 0x10002
  s_add_u32 s7, s7, s5
  s_lshr_b32 s4, s7, 2
  s_lshl_b32 s4, s4, 15
  s_and_b32 s5, s7, 3
  s_lshl_b32 s5, s5, 13
  s_add_u32 s4, s4, s5
  s_add_u32 s6, s4, 589824
  v_lshrrev_b32 v12, 5, v1
  v_lshlrev_b32 v12, 12, v12
  v_lshl_add_u32 v12, v9, 7, v12
  v_lshl_add_u32 v12, v10, 4, v12
  s_mov_b32 s83, 0
  v_mov_b32 v13, 0
L_rdy_11:
  ds_read_b32 v14, v13 offset:12
  s_waitcnt lgkmcnt(0)
  v_cmp_ne_u32 vcc, 1, v14
  s_cbranch_vccz L_rok_12
  s_add_u32 s83, s83, 1
  s_cmp_lt_u32 s83, 1600000
  s_cbranch_scc0 L_rok_12
  s_sleep 1
  s_branch L_rdy_11
L_rok_12:
  ds_read_b32 v14, v13 offset:4
  s_waitcnt lgkmcnt(0)
  v_readfirstlane_b32 s79, v14
  s_cmp_eq_u32 s79, 1
  s_cselect_b32 s5, 0, 3145728
  s_add_u32 s6, s6, s5
  v_add_u32 v12, s6, v12
  s_mov_b32 s83, 0
L_hfull_13:
  buffer_load_dwordx4 v[184:187], v12, s[48:51], 0 offen offset:0 sc1
  buffer_load_dwordx4 v[188:191], v12, s[48:51], 0 offen offset:512 sc1
  buffer_load_dwordx4 v[192:195], v12, s[48:51], 0 offen offset:1024 sc1
  buffer_load_dwordx4 v[196:199], v12, s[48:51], 0 offen offset:1536 sc1
  buffer_load_dwordx4 v[200:203], v12, s[48:51], 0 offen offset:2048 sc1
  buffer_load_dwordx4 v[204:207], v12, s[48:51], 0 offen offset:2560 sc1
  buffer_load_dwordx4 v[208:211], v12, s[48:51], 0 offen offset:3072 sc1
  buffer_load_dwordx4 v[212:215], v12, s[48:51], 0 offen offset:3584 sc1
  s_waitcnt vmcnt(0)
  v_xor_b32 v184, s68, v184
  v_xor_b32 v185, s69, v185
  v_xor_b32 v186, s70, v186
  v_xor_b32 v187, s71, v187
  v_xor_b32 v188, s68, v188
  v_xor_b32 v189, s69, v189
  v_xor_b32 v190, s70, v190
  v_xor_b32 v191, s71, v191
  v_xor_b32 v192, s68, v192
  v_xor_b32 v193, s69, v193
  v_xor_b32 v194, s70, v194
  v_xor_b32 v195, s71, v195
  v_xor_b32 v196, s68, v196
  v_xor_b32 v197, s69, v197
  v_xor_b32 v198, s70, v198
  v_xor_b32 v199, s71, v199
  v_xor_b32 v200, s68, v200
  v_xor_b32 v201, s69, v201
  v_xor_b32 v202, s70, v202
  v_xor_b32 v203, s71, v203
  v_xor_b32 v204, s68, v204
  v_xor_b32 v205, s69, v205
  v_xor_b32 v206, s70, v206
  v_xor_b32 v207, s71, v207
  v_xor_b32 v208, s68, v208
  v_xor_b32 v209, s69, v209
  v_xor_b32 v210, s70, v210
  v_xor_b32 v211, s71, v211
  v_xor_b32 v212, s68, v212
  v_xor_b32 v213, s69, v213
  v_xor_b32 v214, s70, v214
  v_xor_b32 v215, s71, v215
  v_or3_b32 v13, v184, v185, v186
  v_or3_b32 v13, v13, v187, v188
  v_or3_b32 v13, v13, v189, v190
  v_or3_b32 v13, v13, v191, v192
  v_or3_b32 v13, v13, v193, v194
  v_or3_b32 v13, v13, v195, v196
  v_or3_b32 v13, v13, v197, v198
  v_or3_b32 v13, v13, v199, v200
  v_or3_b32 v13, v13, v201, v202
  v_or3_b32 v13, v13, v203, v204
  v_or3_b32 v13, v13, v205, v206
  v_or3_b32 v13, v13, v207, v208
  v_or3_b32 v13, v13, v209, v210
  v_or3_b32 v13, v13, v211, v212
  v_or3_b32 v13, v13, v213, v214
  v_or_b32 v13, v13, v215
  v_and_b32 v13, v8, v13
  v_cmp_ne_u32 vcc, 0, v13
  s_cbranch_vccz L_ok_14
  s_add_u32 s83, s83, 1
  s_cmp_lt_u32 s83, 200000
  s_cbranch_scc0 L_ok_14
  s_branch L_hfull_13
L_ok_14:
  v_add_f32 v184, v184, v188
  v_add_f32 v185, v185, v189
  v_add_f32 v186, v186, v190
  v_add_f32 v187, v187, v191
  v_add_f32 v184, v184, v192
  v_add_f32 v185, v185, v193
  v_add_f32 v186, v186, v194
  v_add_f32 v187, v187, v195
  v_add_f32 v184, v184, v196
  v_add_f32 v185, v185, v197
  v_add_f32 v186, v186, v198
  v_add_f32 v187, v187, v199
  v_add_f32 v184, v184, v200
  v_add_f32 v185, v185, v201
  v_add_f32 v186, v186, v202
  v_add_f32 v187, v187, v203
  v_add_f32 v184, v184, v204
  v_add_f32 v185, v185, v205
  v_add_f32 v186, v186, v206
  v_add_f32 v187, v187, v207
  v_add_f32 v184, v184, v208
  v_add_f32 v185, v185, v209
  v_add_f32 v186, v186, v210
  v_add_f32 v187, v187, v211
  v_add_f32 v184, v184, v212
  v_add_f32 v185, v185, v213
  v_add_f32 v186, v186, v214
  v_add_f32 v187, v187, v215
  v_cvt_pk_bf16_f32 v184, v184, v185
  v_cvt_pk_bf16_f32 v186, v186, v187
  v_and_b32 v185, 0xffff0000, v184
  v_lshlrev_b32 v184, 16, v184
  v_and_b32 v187, 0xffff0000, v186
  v_lshlrev_b32 v186, 16, v186
  v_mov_b32 v188, v184
  v_mov_b32 v189, v185
  v_mov_b32 v190, v186
  v_mov_b32 v191, v187
  v_permlane32_swap_b32 v184, v188
  v_permlane32_swap_b32 v185, v189
  v_permlane32_swap_b32 v186, v190
  v_permlane32_swap_b32 v187, v191
  s_mov_b32 s4, 0x3d372713
  s_mov_b32 s5, 0xc0135761
  v_mul_f32 v192, v184, v184
  v_mul_f32 v192, s4, v192
  v_fma_f32 v192, v192, v184, v184
  v_mul_f32 v192, s5, v192
  v_exp_f32 v192, v192
  s_nop 0
  v_add_f32 v192, 1.0, v192
  v_rcp_f32 v192, v192
  s_nop 0
  v_mul_f32 v192, v192, v184
  v_mul_f32 v193, v185, v185
  v_mul_f32 v193, s4, v193
  v_fma_f32 v193, v193, v185, v185
  v_mul_f32 v193, s5, v193
  v_exp_f32 v193, v193
  s_nop 0
  v_add_f32 v193, 1.0, v193
  v_rcp_f32 v193, v193
  s_nop 0
  v_mul_f32 v193, v193, v185
  v_mul_f32 v194, v186, v186
  v_mul_f32 v194, s4, v194
  v_fma_f32 v194, v194, v186, v186
  v_mul_f32 v194, s5, v194
  v_exp_f32 v194, v194
  s_nop 0
  v_add_f32 v194, 1.0, v194
  v_rcp_f32 v194, v194
  s_nop 0
  v_mul_f32 v194, v194, v186
  v_mul_f32 v195, v187, v187
  v_mul_f32 v195, s4, v195
  v_fma_f32 v195, v195, v187, v187
  v_mul_f32 v195, s5, v195
  v_exp_f32 v195, v195
  s_nop 0
  v_add_f32 v195, 1.0, v195
  v_rcp_f32 v195, v195
  s_nop 0
  v_mul_f32 v195, v195, v187
  v_cvt_pk_bf16_f32 v192, v192, v193
  v_cvt_pk_bf16_f32 v194, v194, v195
  v_and_b32 v193, 0xffff0000, v192
  v_lshlrev_b32 v192, 16, v192
  v_and_b32 v195, 0xffff0000, v194
  v_lshlrev_b32 v194, 16, v194
  v_mul_f32 v192, v192, v188
  v_mul_f32 v193, v193, v189
  v_mul_f32 v194, v194, v190
  v_mul_f32 v195, v195, v191
  v_cvt_pk_bf16_f32 v184, v192, v193
  v_cvt_pk_bf16_f32 v185, v194, v195
  s_branch L_h_wr
L_h_zero:
  v_mov_b32 v184, 0
  v_mov_b32 v185, 0
L_h_wr:
  s_mov_b32 exec_hi, 0
  ds_write_b64 v11, v[184:185] offset:29376
  s_mov_b64 exec, -1
  s_branch L_stream
L_genbar:
  s_barrier
L_stream:
  s_add_i32 s4, s100, 0
  s_mov_b32 s83, 0
  v_mov_b32 v9, 0
L_gate_15:
  ds_read_b32 v10, v9 offset:8
  s_waitcnt lgkmcnt(0)
  v_readfirstlane_b32 s5, v10
  s_cmp_ge_i32 s5, s4
  s_cbranch_scc1 L_gok_16
  s_add_u32 s83, s83, 1
  s_cmp_lt_u32 s83, 1600000
  s_cbranch_scc0 L_gok_16
  s_sleep 1
  s_branch L_gate_15
L_gok_16:
  buffer_load_dwordx4 v[16:19], v4, s[40:43], 0 offen offset:0 nt
  buffer_load_dwordx4 v[20:23], v4, s[40:43], 0 offen offset:128 nt
  buffer_load_dwordx4 v[24:27], v4, s[40:43], 0 offen offset:512 nt
  buffer_load_dwordx4 v[28:31], v4, s[40:43], 0 offen offset:640 nt
  buffer_load_dwordx4 v[32:35], v4, s[40:43], s9 offen offset:0 nt
  buffer_load_dwordx4 v[36:39], v4, s[40:43], s9 offen offset:128 nt
  buffer_load_dwordx4 v[40:43], v4, s[40:43], s9 offen offset:512 nt
  buffer_load_dwordx4 v[44:47], v4, s[40:43], s9 offen offset:640 nt
  s_add_i32 s4, s100, 1
  s_mov_b32 s83, 0
  v_mov_b32 v9, 0
L_gate_17:
  ds_read_b32 v10, v9 offset:8
  s_waitcnt lgkmcnt(0)
  v_readfirstlane_b32 s5, v10
  s_cmp_ge_i32 s5, s4
  s_cbranch_scc1 L_gok_18
  s_add_u32 s83, s83, 1
  s_cmp_lt_u32 s83, 1600000
  s_cbranch_scc0 L_gok_18
  s_sleep 1
  s_branch L_gate_17
L_gok_18:
  buffer_load_dwordx4 v[48:51], v4, s[40:43], s10 offen offset:0 nt
  buffer_load_dwordx4 v[52:55], v4, s[40:43], s10 offen offset:128 nt
  buffer_load_dwordx4 v[56:59], v4, s[40:43], s10 offen offset:512 nt
  buffer_load_dwordx4 v[60:63], v4, s[40:43], s10 offen offset:640 nt
  buffer_load_dwordx4 v[64:67], v4, s[40:43], s11 offen offset:0 nt
  buffer_load_dwordx4 v[68:71], v4, s[40:43], s11 offen offset:128 nt
  buffer_load_dwordx4 v[72:75], v4, s[40:43], s11 offen offset:512 nt
  buffer_load_dwordx4 v[76:79], v4, s[40:43], s11 offen offset:640 nt
L_stream_k_done:
  s_waitcnt vmcnt(8)
  v_mov_b32 v9, 0
  v_mov_b32 v10, 1
  s_mov_b64 exec, 1
  ds_add_u32 v9, v10 offset:8
  s_mov_b64 exec, -1
  s_waitcnt vmcnt(0)
  v_mov_b32 v9, 0
  v_mov_b32 v10, 1
  s_mov_b64 exec, 1
  ds_add_u32 v9, v10 offset:8
  s_mov_b64 exec, -1
  s_cmp_lt_u32 s78, 2
  s_cbranch_scc1 L_flowE
  s_add_i32 s4, s101, 0
  s_mov_b32 s83, 0
  v_mov_b32 v9, 0
L_gate_19:
  ds_read_b32 v10, v9 offset:8
  s_waitcnt lgkmcnt(0)
  v_readfirstlane_b32 s5, v10
  s_cmp_ge_i32 s5, s4
  s_cbranch_scc1 L_gok_20
  s_add_u32 s83, s83, 1
  s_cmp_lt_u32 s83, 1600000
  s_cbranch_scc0 L_gok_20
  s_sleep 1
  s_branch L_gate_19
L_gok_20:
  buffer_load_dwordx4 v[80:83], v5, s[44:47], 0 offen offset:0 nt
  buffer_load_dwordx4 v[84:87], v5, s[44:47], 0 offen offset:1024 nt
  buffer_load_dwordx4 v[88:91], v5, s[44:47], 0 offen offset:2048 nt
  buffer_load_dwordx4 v[92:95], v5, s[44:47], 0 offen offset:3072 nt
  buffer_load_dwordx4 v[96:99], v5, s[44:47], s9 offen offset:0 nt
  buffer_load_dwordx4 v[100:103], v5, s[44:47], s9 offen offset:1024 nt
  buffer_load_dwordx4 v[104:107], v5, s[44:47], s9 offen offset:2048 nt
  buffer_load_dwordx4 v[108:111], v5, s[44:47], s9 offen offset:3072 nt
  s_add_i32 s4, s101, 1
  s_mov_b32 s83, 0
  v_mov_b32 v9, 0
L_gate_21:
  ds_read_b32 v10, v9 offset:8
  s_waitcnt lgkmcnt(0)
  v_readfirstlane_b32 s5, v10
  s_cmp_ge_i32 s5, s4
  s_cbranch_scc1 L_gok_22
  s_add_u32 s83, s83, 1
  s_cmp_lt_u32 s83, 1600000
  s_cbranch_scc0 L_gok_22
  s_sleep 1
  s_branch L_gate_21
L_gok_22:
  buffer_load_dwordx4 v[112:115], v5, s[44:47], s10 offen offset:0 nt
  buffer_load_dwordx4 v[116:119], v5, s[44:47], s10 offen offset:1024 nt
  buffer_load_dwordx4 v[120:123], v5, s[44:47], s10 offen offset:2048 nt
  buffer_load_dwordx4 v[124:127], v5, s[44:47], s10 offen offset:3072 nt
  buffer_load_dwordx4 v[128:131], v5, s[44:47], s11 offen offset:0 nt
  buffer_load_dwordx4 v[132:135], v5, s[44:47], s11 offen offset:1024 nt
  buffer_load_dwordx4 v[136:139], v5, s[44:47], s11 offen offset:2048 nt
  buffer_load_dwordx4 v[140:143], v5, s[44:47], s11 offen offset:3072 nt
  v_mov_b32 v9, 0
  ds_read_b32 v10, v9 offset:0
  s_waitcnt lgkmcnt(0)
  v_cmp_ne_u32 vcc, 1, v10
  s_cbranch_vccnz L_notready
  v_and_b32 v9, 3, v3
  v_mul_u32_u24 v9, 320, v9
  v_lshl_add_u32 v9, v2, 4, v9
  ds_read_b128 v[144:147], v9 offset:64
  ds_read_b128 v[148:151], v9 offset:128
  ds_read_b128 v[152:155], v9 offset:192
  ds_read_b128 v[156:159], v9 offset:256
  s_waitcnt lgkmcnt(0)
  v_mfma_f32_16x16x32_bf16 v[160:163], v[16:19], v[144:147], 0
  v_mfma_f32_16x16x32_bf16 v[232:235], v[16:19], v[148:151], 0
  v_mfma_f32_16x16x32_bf16 v[236:239], v[24:27], v[144:147], 0
  v_mfma_f32_16x16x32_bf16 v[240:243], v[24:27], v[148:151], 0
  v_mfma_f32_16x16x32_bf16 v[160:163], v[20:23], v[152:155], v[160:163]
  v_mfma_f32_16x16x32_bf16 v[232:235], v[20:23], v[156:159], v[232:235]
  v_mfma_f32_16x16x32_bf16 v[236:239], v[28:31], v[152:155], v[236:239]
  v_mfma_f32_16x16x32_bf16 v[240:243], v[28:31], v[156:159], v[240:243]
  v_mfma_f32_16x16x32_bf16 v[164:167], v[32:35], v[144:147], 0
  v_mfma_f32_16x16x32_bf16 v[244:247], v[32:35], v[148:151], 0
  v_mfma_f32_16x16x32_bf16 v[248:251], v[40:43], v[144:147], 0
  v_mfma_f32_16x16x32_bf16 v[252:255], v[40:43], v[148:151], 0
  v_mfma_f32_16x16x32_bf16 v[164:167], v[36:39], v[152:155], v[164:167]
  v_mfma_f32_16x16x32_bf16 v[244:247], v[36:39], v[156:159], v[244:247]
  v_mfma_f32_16x16x32_bf16 v[248:251], v[44:47], v[152:155], v[248:251]
  v_mfma_f32_16x16x32_bf16 v[252:255], v[44:47], v[156:159], v[252:255]
  v_permlane32_swap_b32 v160, v236
  v_permlane32_swap_b32 v232, v240
  v_permlane32_swap_b32 v161, v237
  v_permlane32_swap_b32 v233, v241
  v_permlane32_swap_b32 v162, v238
  v_permlane32_swap_b32 v234, v242
  v_permlane32_swap_b32 v163, v239
  v_permlane32_swap_b32 v235, v243
  v_add_f32 v160, v160, v240
  v_add_f32 v161, v161, v241
  v_add_f32 v162, v162, v242
  v_add_f32 v163, v163, v243
  v_mfma_f32_16x16x32_bf16 v[168:171], v[48:51], v[144:147], 0
  v_mfma_f32_16x16x32_bf16 v[232:235], v[48:51], v[148:151], 0
  v_mfma_f32_16x16x32_bf16 v[236:239], v[56:59], v[144:147], 0
  v_mfma_f32_16x16x32_bf16 v[240:243], v[56:59], v[148:151], 0
  v_mfma_f32_16x16x32_bf16 v[168:171], v[52:55], v[152:155], v[168:171]
  v_mfma_f32_16x16x32_bf16 v[232:235], v[52:55], v[156:159], v[232:235]
  v_mfma_f32_16x16x32_bf16 v[236:239], v[60:63], v[152:155], v[236:239]
  v_mfma_f32_16x16x32_bf16 v[240:243], v[60:63], v[156:159], v[240:243]
  v_permlane32_swap_b32 v164, v248
  v_permlane32_swap_b32 v244, v252
  v_permlane32_swap_b32 v165, v249
  v_permlane32_swap_b32 v245, v253
  v_permlane32_swap_b32 v166, v250
  v_permlane32_swap_b32 v246, v254
  v_permlane32_swap_b32 v167, v251
  v_permlane32_swap_b32 v247, v255
  v_add_f32 v164, v164, v252
  v_add_f32 v165, v165, v253
  v_add_f32 v166, v166, v254
  v_add_f32 v167, v167, v255
  v_mfma_f32_16x16x32_bf16 v[172:175], v[64:67], v[144:147], 0
  v_mfma_f32_16x16x32_bf16 v[244:247], v[64:67], v[148:151], 0
  v_mfma_f32_16x16x32_bf16 v[248:251], v[72:75], v[144:147], 0
  v_mfma_f32_16x16x32_bf16 v[252:255], v[72:75], v[148:151], 0
  v_mfma_f32_16x16x32_bf16 v[172:175], v[68:71], v[152:155], v[172:175]
  v_mfma_f32_16x16x32_bf16 v[244:247], v[68:71], v[156:159], v[244:247]
  v_mfma_f32_16x16x32_bf16 v[248:251], v[76:79], v[152:155], v[248:251]
  v_mfma_f32_16x16x32_bf16 v[252:255], v[76:79], v[156:159], v[252:255]
  v_permlane32_swap_b32 v168, v236
  v_permlane32_swap_b32 v232, v240
  v_permlane32_swap_b32 v169, v237
  v_permlane32_swap_b32 v233, v241
  v_permlane32_swap_b32 v170, v238
  v_permlane32_swap_b32 v234, v242
  v_permlane32_swap_b32 v171, v239
  v_permlane32_swap_b32 v235, v243
  v_add_f32 v168, v168, v240
  v_add_f32 v169, v169, v241
  v_add_f32 v170, v170, v242
  v_add_f32 v171, v171, v243
  v_permlane32_swap_b32 v172, v248
  v_permlane32_swap_b32 v244, v252
  v_permlane32_swap_b32 v173, v249
  v_permlane32_swap_b32 v245, v253
  v_permlane32_swap_b32 v174, v250
  v_permlane32_swap_b32 v246, v254
  v_permlane32_swap_b32 v175, v251
  v_permlane32_swap_b32 v247, v255
  v_add_f32 v172, v172, v252
  v_add_f32 v173, v173, v253
  v_add_f32 v174, v174, v254
  v_add_f32 v175, v175, v255
  s_mov_b32 s4, 0x3db504f3
  v_cvt_pk_bf16_f32 v161, v160, v161
  v_lshlrev_b32 v160, 16, v161
  v_and_b32 v161, 0xffff0000, v161
  v_mul_f32 v160, s4, v160
  v_mul_f32 v161, s4, v161
  v_cvt_pk_bf16_f32 v161, v160, v161
  v_lshlrev_b32 v160, 16, v161
  v_and_b32 v161, 0xffff0000, v161
  v_cvt_pk_bf16_f32 v163, v162, v163
  v_lshlrev_b32 v162, 16, v163
  v_and_b32 v163, 0xffff0000, v163
  v_mul_f32 v162, s4, v162
  v_mul_f32 v163, s4, v163
  v_cvt_pk_bf16_f32 v163, v162, v163
  v_lshlrev_b32 v162, 16, v163
  v_and_b32 v163, 0xffff0000, v163
  v_cvt_pk_bf16_f32 v165, v164, v165
  v_lshlrev_b32 v164, 16, v165
  v_and_b32 v165, 0xffff0000, v165
  v_mul_f32 v164, s4, v164
  v_mul_f32 v165, s4, v165
  v_cvt_pk_bf16_f32 v165, v164, v165
  v_lshlrev_b32 v164, 16, v165
  v_and_b32 v165, 0xffff0000, v165
  v_cvt_pk_bf16_f32 v167, v166, v167
  v_lshlrev_b32 v166, 16, v167
  v_and_b32 v167, 0xffff0000, v167
  v_mul_f32 v166, s4, v166
  v_mul_f32 v167, s4, v167
  v_cvt_pk_bf16_f32 v167, v166, v167
  v_lshlrev_b32 v166, 16, v167
  v_and_b32 v167, 0xffff0000, v167
  v_cvt_pk_bf16_f32 v169, v168, v169
  v_lshlrev_b32 v168, 16, v169
  v_and_b32 v169, 0xffff0000, v169
  v_mul_f32 v168, s4, v168
  v_mul_f32 v169, s4, v169
  v_cvt_pk_bf16_f32 v169, v168, v169
  v_lshlrev_b32 v168, 16, v169
  v_and_b32 v169, 0xffff0000, v169
  v_cvt_pk_bf16_f32 v171, v170, v171
  v_lshlrev_b32 v170, 16, v171
  v_and_b32 v171, 0xffff0000, v171
  v_mul_f32 v170, s4, v170
  v_mul_f32 v171, s4, v171
  v_cvt_pk_bf16_f32 v171, v170, v171
  v_lshlrev_b32 v170, 16, v171
  v_and_b32 v171, 0xffff0000, v171
  v_cvt_pk_bf16_f32 v173, v172, v173
  v_lshlrev_b32 v172, 16, v173
  v_and_b32 v173, 0xffff0000, v173
  v_mul_f32 v172, s4, v172
  v_mul_f32 v173, s4, v173
  v_cvt_pk_bf16_f32 v173, v172, v173
  v_lshlrev_b32 v172, 16, v173
  v_and_b32 v173, 0xffff0000, v173
  v_cvt_pk_bf16_f32 v175, v174, v175
  v_lshlrev_b32 v174, 16, v175
  v_and_b32 v175, 0xffff0000, v175
  v_mul_f32 v174, s4, v174
  v_mul_f32 v175, s4, v175
  v_cvt_pk_bf16_f32 v175, v174, v175
  v_lshlrev_b32 v174, 16, v175
  v_and_b32 v175, 0xffff0000, v175
  v_max3_f32 v9, v160, v161, v162
  v_max3_f32 v9, v9, v163, v164
  v_max3_f32 v9, v9, v165, v166
  v_max3_f32 v9, v9, v167, v168
  v_max3_f32 v9, v9, v169, v170
  v_max3_f32 v9, v9, v171, v172
  v_max3_f32 v9, v9, v173, v174
  v_max_f32 v9, v9, v175
  v_mov_b32 v10, v9
  s_nop 1
  v_permlane32_swap_b32 v9, v10
  v_max_f32 v9, v9, v10
  v_mov_b32 v10, v9
  s_nop 1
  v_permlane16_swap_b32 v9, v10
  v_max_f32 v9, v9, v10
  s_mov_b32 s4, 0x3fb8aa3b
  v_mul_f32 v9, s4, v9
  v_bfi_b32 v9, v8, 0, v9
  v_fma_f32 v160, v160, s4, -v9
  v_fma_f32 v161, v161, s4, -v9
  v_fma_f32 v162, v162, s4, -v9
  v_fma_f32 v163, v163, s4, -v9
  v_fma_f32 v164, v164, s4, -v9
  v_fma_f32 v165, v165, s4, -v9
  v_fma_f32 v166, v166, s4, -v9
  v_fma_f32 v167, v167, s4, -v9
  v_fma_f32 v168, v168, s4, -v9
  v_fma_f32 v169, v169, s4, -v9
  v_fma_f32 v170, v170, s4, -v9
  v_fma_f32 v171, v171, s4, -v9
  v_fma_f32 v172, v172, s4, -v9
  v_fma_f32 v173, v173, s4, -v9
  v_fma_f32 v174, v174, s4, -v9
  v_fma_f32 v175, v175, s4, -v9
  v_exp_f32 v160, v160
  v_exp_f32 v161, v161
  v_exp_f32 v162, v162
  v_exp_f32 v163, v163
  v_exp_f32 v164, v164
  v_exp_f32 v165, v165
  v_exp_f32 v166, v166
  v_exp_f32 v167, v167
  v_exp_f32 v168, v168
  v_exp_f32 v169, v169
  v_exp_f32 v170, v170
  v_exp_f32 v171, v171
  v_exp_f32 v172, v172
  v_exp_f32 v173, v173
  v_exp_f32 v174, v174
  v_exp_f32 v175, v175
  v_cvt_pk_bf16_f32 v176, v160, v161
  v_cvt_pk_bf16_f32 v177, v162, v163
  v_cvt_pk_bf16_f32 v178, v164, v165
  v_cvt_pk_bf16_f32 v179, v166, v167
  v_cvt_pk_bf16_f32 v180, v168, v169
  v_cvt_pk_bf16_f32 v181, v170, v171
  v_cvt_pk_bf16_f32 v182, v172, v173
  v_cvt_pk_bf16_f32 v183, v174, v175
  v_lshlrev_b32 v160, 16, v176
  v_and_b32 v161, 0xffff0000, v176
  v_lshlrev_b32 v162, 16, v177
  v_and_b32 v163, 0xffff0000, v177
  v_lshlrev_b32 v164, 16, v178
  v_and_b32 v165, 0xffff0000, v178
  v_lshlrev_b32 v166, 16, v179
  v_and_b32 v167, 0xffff0000, v179
  v_lshlrev_b32 v168, 16, v180
  v_and_b32 v169, 0xffff0000, v180
  v_lshlrev_b32 v170, 16, v181
  v_and_b32 v171, 0xffff0000, v181
  v_lshlrev_b32 v172, 16, v182
  v_and_b32 v173, 0xffff0000, v182
  v_lshlrev_b32 v174, 16, v183
  v_and_b32 v175, 0xffff0000, v183
  v_add_f32 v160, v160, v168
  v_add_f32 v161, v161, v169
  v_add_f32 v162, v162, v170
  v_add_f32 v163, v163, v171
  v_add_f32 v164, v164, v172
  v_add_f32 v165, v165, v173
  v_add_f32 v166, v166, v174
  v_add_f32 v167, v167, v175
  v_add_f32 v160, v160, v164
  v_add_f32 v161, v161, v165
  v_add_f32 v162, v162, v166
  v_add_f32 v163, v163, v167
  v_add_f32 v160, v160, v162
  v_add_f32 v161, v161, v163
  v_add_f32 v10, v160, v161
  v_mov_b32 v11, v10
  s_nop 1
  v_permlane32_swap_b32 v10, v11
  v_add_f32 v10, v10, v11
  v_mov_b32 v11, v10
  s_nop 1
  v_permlane16_swap_b32 v10, v11
  v_add_f32 v10, v10, v11
  s_lshl_b32 s4, s78, 2
  v_lshlrev_b32 v11, 5, v3
  v_add_u32 v11, s4, v11
  s_mov_b32 exec_lo, 0xf
  s_mov_b32 exec_hi, 0
  ds_write_b32 v11, v9 offset:28544
  ds_write_b32 v11, v10 offset:28672
  s_mov_b64 exec, 1
  v_mov_b32 v9, 0
  v_mov_b32 v10, 1
  s_waitcnt lgkmcnt(0)
  ds_add_u32 v9, v10 offset:16
  s_mov_b64 exec, -1
  s_mov_b32 s80, 0x05040100
  s_mov_b32 s81, 0x07060302
  s_mul_i32 s4, s78, 2304
  v_mul_u32_u24 v11, 576, v3
  v_lshl_add_u32 v11, v2, 4, v11
  v_add_u32 v11, s4, v11
  s_waitcnt vmcnt(8)
  v_mov_b32 v9, 0
  v_mov_b32 v10, 1
  s_mov_b64 exec, 1
  ds_add_u32 v9, v10 offset:8
  s_mov_b64 exec, -1
  v_perm_b32 v16, v84, v80, s80
  v_perm_b32 v20, v84, v80, s81
  v_perm_b32 v24, v85, v81, s80
  v_perm_b32 v28, v85, v81, s81
  v_perm_b32 v32, v86, v82, s80
  v_perm_b32 v36, v86, v82, s81
  v_perm_b32 v40, v87, v83, s80
  v_perm_b32 v44, v87, v83, s81
  v_perm_b32 v17, v92, v88, s80
  v_perm_b32 v21, v92, v88, s81
  v_perm_b32 v25, v93, v89, s80
  v_perm_b32 v29, v93, v89, s81
  v_perm_b32 v33, v94, v90, s80
  v_perm_b32 v37, v94, v90, s81
  v_perm_b32 v41, v95, v91, s80
  v_perm_b32 v45, v95, v91, s81
  v_perm_b32 v18, v100, v96, s80
  v_perm_b32 v22, v100, v96, s81
  v_perm_b32 v26, v101, v97, s80
  v_perm_b32 v30, v101, v97, s81
  v_perm_b32 v34, v102, v98, s80
  v_perm_b32 v38, v102, v98, s81
  v_perm_b32 v42, v103, v99, s80
  v_perm_b32 v46, v103, v99, s81
  v_perm_b32 v19, v108, v104, s80
  v_perm_b32 v23, v108, v104, s81
  v_perm_b32 v27, v109, v105, s80
  v_perm_b32 v31, v109, v105, s81
  v_perm_b32 v35, v110, v106, s80
  v_perm_b32 v39, v110, v106, s81
  v_perm_b32 v43, v111, v107, s80
  v_perm_b32 v47, v111, v107, s81
  v_mfma_f32_16x16x32_bf16 v[48:51], v[16:19], v[176:179], 0
  v_mfma_f32_16x16x32_bf16 v[52:55], v[20:23], v[176:179], 0
  v_mfma_f32_16x16x32_bf16 v[56:59], v[24:27], v[176:179], 0
  v_mfma_f32_16x16x32_bf16 v[60:63], v[28:31], v[176:179], 0
  v_mfma_f32_16x16x32_bf16 v[64:67], v[32:35], v[176:179], 0
  v_mfma_f32_16x16x32_bf16 v[68:71], v[36:39], v[176:179], 0
  v_mfma_f32_16x16x32_bf16 v[72:75], v[40:43], v[176:179], 0
  v_mfma_f32_16x16x32_bf16 v[76:79], v[44:47], v[176:179], 0
  s_waitcnt vmcnt(6)
  v_perm_b32 v16, v116, v112, s80
  v_perm_b32 v20, v116, v112, s81
  v_perm_b32 v24, v117, v113, s80
  v_perm_b32 v28, v117, v113, s81
  v_perm_b32 v32, v118, v114, s80
  v_perm_b32 v36, v118, v114, s81
  v_perm_b32 v40, v119, v115, s80
  v_perm_b32 v44, v119, v115, s81
  s_waitcnt vmcnt(4)
  v_perm_b32 v17, v124, v120, s80
  v_perm_b32 v21, v124, v120, s81
  v_perm_b32 v25, v125, v121, s80
  v_perm_b32 v29, v125, v121, s81
  v_perm_b32 v33, v126, v122, s80
  v_perm_b32 v37, v126, v122, s81
  v_perm_b32 v41, v127, v123, s80
  v_perm_b32 v45, v127, v123, s81
  s_waitcnt vmcnt(2)
  v_perm_b32 v18, v132, v128, s80
  v_perm_b32 v22, v132, v128, s81
  v_perm_b32 v26, v133, v129, s80
  v_perm_b32 v30, v133, v129, s81
  v_perm_b32 v34, v134, v130, s80
  v_perm_b32 v38, v134, v130, s81
  v_perm_b32 v42, v135, v131, s80
  v_perm_b32 v46, v135, v131, s81
  s_waitcnt vmcnt(0)
  v_mov_b32 v9, 0
  v_mov_b32 v10, 1
  s_mov_b64 exec, 1
  ds_add_u32 v9, v10 offset:8
  s_mov_b64 exec, -1
  v_perm_b32 v19, v140, v136, s80
  v_perm_b32 v23, v140, v136, s81
  v_perm_b32 v27, v141, v137, s80
  v_perm_b32 v31, v141, v137, s81
  v_perm_b32 v35, v142, v138, s80
  v_perm_b32 v39, v142, v138, s81
  v_perm_b32 v43, v143, v139, s80
  v_perm_b32 v47, v143, v139, s81
  v_mfma_f32_16x16x32_bf16 v[48:51], v[16:19], v[180:183], v[48:51]
  v_mfma_f32_16x16x32_bf16 v[52:55], v[20:23], v[180:183], v[52:55]
  v_mfma_f32_16x16x32_bf16 v[56:59], v[24:27], v[180:183], v[56:59]
  v_mfma_f32_16x16x32_bf16 v[60:63], v[28:31], v[180:183], v[60:63]
  v_mfma_f32_16x16x32_bf16 v[64:67], v[32:35], v[180:183], v[64:67]
  v_mfma_f32_16x16x32_bf16 v[68:71], v[36:39], v[180:183], v[68:71]
  v_mfma_f32_16x16x32_bf16 v[72:75], v[40:43], v[180:183], v[72:75]
  v_mfma_f32_16x16x32_bf16 v[76:79], v[44:47], v[180:183], v[76:79]
  s_mov_b32 exec_lo, 0x000f000f
  s_mov_b32 exec_hi, 0x000f000f
  ds_write_b128 v11, v[48:51] offset:10112
  ds_write_b128 v11, v[52:55] offset:10176
  ds_write_b128 v11, v[56:59] offset:10240
  ds_write_b128 v11, v[60:63] offset:10304
  ds_write_b128 v11, v[64:67] offset:10368
  ds_write_b128 v11, v[68:71] offset:10432
  ds_write_b128 v11, v[72:75] offset:10496
  ds_write_b128 v11, v[76:79] offset:10560
  s_mov_b64 exec, -1
  s_branch L_pvdone
L_notready:
  s_waitcnt vmcnt(8)
  v_mov_b32 v9, 0
  v_mov_b32 v10, 1
  s_mov_b64 exec, 1
  ds_add_u32 v9, v10 offset:8
  s_mov_b64 exec, -1
  s_waitcnt vmcnt(0)
  v_mov_b32 v9, 0
  v_mov_b32 v10, 1
  s_mov_b64 exec, 1
  ds_add_u32 v9, v10 offset:8
  s_mov_b64 exec, -1
  s_mov_b32 s83, 0
  v_mov_b32 v9, 0
L_qflag_23:
  ds_read_b32 v10, v9 offset:0
  s_waitcnt lgkmcnt(0)
  v_cmp_ne_u32 vcc, 1, v10
  s_cbranch_vccz L_ok_24
  s_add_u32 s83, s83, 1
  s_cmp_lt_u32 s83, 1600000
  s_cbranch_scc0 L_ok_24
  s_sleep 1
  s_branch L_qflag_23
L_ok_24:
  v_and_b32 v9, 3, v3
  v_mul_u32_u24 v9, 320, v9
  v_lshl_add_u32 v9, v2, 4, v9
  ds_read_b128 v[144:147], v9 offset:64
  ds_read_b128 v[148:151], v9 offset:128
  ds_read_b128 v[152:155], v9 offset:192
  ds_read_b128 v[156:159], v9 offset:256
  s_waitcnt lgkmcnt(0)
  v_mfma_f32_16x16x32_bf16 v[160:163], v[16:19], v[144:147], 0
  v_mfma_f32_16x16x32_bf16 v[232:235], v[16:19], v[148:151], 0
  v_mfma_f32_16x16x32_bf16 v[236:239], v[24:27], v[144:147], 0
  v_mfma_f32_16x16x32_bf16 v[240:243], v[24:27], v[148:151], 0
  v_mfma_f32_16x16x32_bf16 v[160:163], v[20:23], v[152:155], v[160:163]
  v_mfma_f32_16x16x32_bf16 v[232:235], v[20:23], v[156:159], v[232:235]
  v_mfma_f32_16x16x32_bf16 v[236:239], v[28:31], v[152:155], v[236:239]
  v_mfma_f32_16x16x32_bf16 v[240:243], v[28:31], v[156:159], v[240:243]
  v_mfma_f32_16x16x32_bf16 v[164:167], v[32:35], v[144:147], 0
  v_mfma_f32_16x16x32_bf16 v[244:247], v[32:35], v[148:151], 0
  v_mfma_f32_16x16x32_bf16 v[248:251], v[40:43], v[144:147], 0
  v_mfma_f32_16x16x32_bf16 v[252:255], v[40:43], v[148:151], 0
  v_mfma_f32_16x16x32_bf16 v[164:167], v[36:39], v[152:155], v[164:167]
  v_mfma_f32_16x16x32_bf16 v[244:247], v[36:39], v[156:159], v[244:247]
  v_mfma_f32_16x16x32_bf16 v[248:251], v[44:47], v[152:155], v[248:251]
  v_mfma_f32_16x16x32_bf16 v[252:255], v[44:47], v[156:159], v[252:255]
  v_permlane32_swap_b32 v160, v236
  v_permlane32_swap_b32 v232, v240
  v_permlane32_swap_b32 v161, v237
  v_permlane32_swap_b32 v233, v241
  v_permlane32_swap_b32 v162, v238
  v_permlane32_swap_b32 v234, v242
  v_permlane32_swap_b32 v163, v239
  v_permlane32_swap_b32 v235, v243
  v_add_f32 v160, v160, v240
  v_add_f32 v161, v161, v241
  v_add_f32 v162, v162, v242
  v_add_f32 v163, v163, v243
  v_mfma_f32_16x16x32_bf16 v[168:171], v[48:51], v[144:147], 0
  v_mfma_f32_16x16x32_bf16 v[232:235], v[48:51], v[148:151], 0
  v_mfma_f32_16x16x32_bf16 v[236:239], v[56:59], v[144:147], 0
  v_mfma_f32_16x16x32_bf16 v[240:243], v[56:59], v[148:151], 0
  v_mfma_f32_16x16x32_bf16 v[168:171], v[52:55], v[152:155], v[168:171]
  v_mfma_f32_16x16x32_bf16 v[232:235], v[52:55], v[156:159], v[232:235]
  v_mfma_f32_16x16x32_bf16 v[236:239], v[60:63], v[152:155], v[236:239]
  v_mfma_f32_16x16x32_bf16 v[240:243], v[60:63], v[156:159], v[240:243]
  v_permlane32_swap_b32 v164, v248
  v_permlane32_swap_b32 v244, v252
  v_permlane32_swap_b32 v165, v249
  v_permlane32_swap_b32 v245, v253
  v_permlane32_swap_b32 v166, v250
  v_permlane32_swap_b32 v246, v254
  v_permlane32_swap_b32 v167, v251
  v_permlane32_swap_b32 v247, v255
  v_add_f32 v164, v164, v252
  v_add_f32 v165, v165, v253
  v_add_f32 v166, v166, v254
  v_add_f32 v167, v167, v255
  v_mfma_f32_16x16x32_bf16 v[172:175], v[64:67], v[144:147], 0
  v_mfma_f32_16x16x32_bf16 v[244:247], v[64:67], v[148:151], 0
  v_mfma_f32_16x16x32_bf16 v[248:251], v[72:75], v[144:147], 0
  v_mfma_f32_16x16x32_bf16 v[252:255], v[72:75], v[148:151], 0
  v_mfma_f32_16x16x32_bf16 v[172:175], v[68:71], v[152:155], v[172:175]
  v_mfma_f32_16x16x32_bf16 v[244:247], v[68:71], v[156:159], v[244:247]
  v_mfma_f32_16x16x32_bf16 v[248:251], v[76:79], v[152:155], v[248:251]
  v_mfma_f32_16x16x32_bf16 v[252:255], v[76:79], v[156:159], v[252:255]
  v_permlane32_swap_b32 v168, v236
  v_permlane32_swap_b32 v232, v240
  v_permlane32_swap_b32 v169, v237
  v_permlane32_swap_b32 v233, v241
  v_permlane32_swap_b32 v170, v238
  v_permlane32_swap_b32 v234, v242
  v_permlane32_swap_b32 v171, v239
  v_permlane32_swap_b32 v235, v243
  v_add_f32 v168, v168, v240
  v_add_f32 v169, v169, v241
  v_add_f32 v170, v170, v242
  v_add_f32 v171, v171, v243
  v_permlane32_swap_b32 v172, v248
  v_permlane32_swap_b32 v244, v252
  v_permlane32_swap_b32 v173, v249
  v_permlane32_swap_b32 v245, v253
  v_permlane32_swap_b32 v174, v250
  v_permlane32_swap_b32 v246, v254
  v_permlane32_swap_b32 v175, v251
  v_permlane32_swap_b32 v247, v255
  v_add_f32 v172, v172, v252
  v_add_f32 v173, v173, v253
  v_add_f32 v174, v174, v254
  v_add_f32 v175, v175, v255
  s_mov_b32 s4, 0x3db504f3
  v_cvt_pk_bf16_f32 v161, v160, v161
  v_lshlrev_b32 v160, 16, v161
  v_and_b32 v161, 0xffff0000, v161
  v_mul_f32 v160, s4, v160
  v_mul_f32 v161, s4, v161
  v_cvt_pk_bf16_f32 v161, v160, v161
  v_lshlrev_b32 v160, 16, v161
  v_and_b32 v161, 0xffff0000, v161
  v_cvt_pk_bf16_f32 v163, v162, v163
  v_lshlrev_b32 v162, 16, v163
  v_and_b32 v163, 0xffff0000, v163
  v_mul_f32 v162, s4, v162
  v_mul_f32 v163, s4, v163
  v_cvt_pk_bf16_f32 v163, v162, v163
  v_lshlrev_b32 v162, 16, v163
  v_and_b32 v163, 0xffff0000, v163
  v_cvt_pk_bf16_f32 v165, v164, v165
  v_lshlrev_b32 v164, 16, v165
  v_and_b32 v165, 0xffff0000, v165
  v_mul_f32 v164, s4, v164
  v_mul_f32 v165, s4, v165
  v_cvt_pk_bf16_f32 v165, v164, v165
  v_lshlrev_b32 v164, 16, v165
  v_and_b32 v165, 0xffff0000, v165
  v_cvt_pk_bf16_f32 v167, v166, v167
  v_lshlrev_b32 v166, 16, v167
  v_and_b32 v167, 0xffff0000, v167
  v_mul_f32 v166, s4, v166
  v_mul_f32 v167, s4, v167
  v_cvt_pk_bf16_f32 v167, v166, v167
  v_lshlrev_b32 v166, 16, v167
  v_and_b32 v167, 0xffff0000, v167
  v_cvt_pk_bf16_f32 v169, v168, v169
  v_lshlrev_b32 v168, 16, v169
  v_and_b32 v169, 0xffff0000, v169
  v_mul_f32 v168, s4, v168
  v_mul_f32 v169, s4, v169
  v_cvt_pk_bf16_f32 v169, v168, v169
  v_lshlrev_b32 v168, 16, v169
  v_and_b32 v169, 0xffff0000, v169
  v_cvt_pk_bf16_f32 v171, v170, v171
  v_lshlrev_b32 v170, 16, v171
  v_and_b32 v171, 0xffff0000, v171
  v_mul_f32 v170, s4, v170
  v_mul_f32 v171, s4, v171
  v_cvt_pk_bf16_f32 v171, v170, v171
  v_lshlrev_b32 v170, 16, v171
  v_and_b32 v171, 0xffff0000, v171
  v_cvt_pk_bf16_f32 v173, v172, v173
  v_lshlrev_b32 v172, 16, v173
  v_and_b32 v173, 0xffff0000, v173
  v_mul_f32 v172, s4, v172
  v_mul_f32 v173, s4, v173
  v_cvt_pk_bf16_f32 v173, v172, v173
  v_lshlrev_b32 v172, 16, v173
  v_and_b32 v173, 0xffff0000, v173
  v_cvt_pk_bf16_f32 v175, v174, v175
  v_lshlrev_b32 v174, 16, v175
  v_and_b32 v175, 0xffff0000, v175
  v_mul_f32 v174, s4, v174
  v_mul_f32 v175, s4, v175
  v_cvt_pk_bf16_f32 v175, v174, v175
  v_lshlrev_b32 v174, 16, v175
  v_and_b32 v175, 0xffff0000, v175
  v_max3_f32 v9, v160, v161, v162
  v_max3_f32 v9, v9, v163, v164
  v_max3_f32 v9, v9, v165, v166
  v_max3_f32 v9, v9, v167, v168
  v_max3_f32 v9, v9, v169, v170
  v_max3_f32 v9, v9, v171, v172
  v_max3_f32 v9, v9, v173, v174
  v_max_f32 v9, v9, v175
  v_mov_b32 v10, v9
  s_nop 1
  v_permlane32_swap_b32 v9, v10
  v_max_f32 v9, v9, v10
  v_mov_b32 v10, v9
  s_nop 1
  v_permlane16_swap_b32 v9, v10
  v_max_f32 v9, v9, v10
  s_mov_b32 s4, 0x3fb8aa3b
  v_mul_f32 v9, s4, v9
  v_bfi_b32 v9, v8, 0, v9
  v_fma_f32 v160, v160, s4, -v9
  v_fma_f32 v161, v161, s4, -v9
  v_fma_f32 v162, v162, s4, -v9
  v_fma_f32 v163, v163, s4, -v9
  v_fma_f32 v164, v164, s4, -v9
  v_fma_f32 v165, v165, s4, -v9
  v_fma_f32 v166, v166, s4, -v9
  v_fma_f32 v167, v167, s4, -v9
  v_fma_f32 v168, v168, s4, -v9
  v_fma_f32 v169, v169, s4, -v9
  v_fma_f32 v170, v170, s4, -v9
  v_fma_f32 v171, v171, s4, -v9
  v_fma_f32 v172, v172, s4, -v9
  v_fma_f32 v173, v173, s4, -v9
  v_fma_f32 v174, v174, s4, -v9
  v_fma_f32 v175, v175, s4, -v9
  v_exp_f32 v160, v160
  v_exp_f32 v161, v161
  v_exp_f32 v162, v162
  v_exp_f32 v163, v163
  v_exp_f32 v164, v164
  v_exp_f32 v165, v165
  v_exp_f32 v166, v166
  v_exp_f32 v167, v167
  v_exp_f32 v168, v168
  v_exp_f32 v169, v169
  v_exp_f32 v170, v170
  v_exp_f32 v171, v171
  v_exp_f32 v172, v172
  v_exp_f32 v173, v173
  v_exp_f32 v174, v174
  v_exp_f32 v175, v175
  v_cvt_pk_bf16_f32 v176, v160, v161
  v_cvt_pk_bf16_f32 v177, v162, v163
  v_cvt_pk_bf16_f32 v178, v164, v165
  v_cvt_pk_bf16_f32 v179, v166, v167
  v_cvt_pk_bf16_f32 v180, v168, v169
  v_cvt_pk_bf16_f32 v181, v170, v171
  v_cvt_pk_bf16_f32 v182, v172, v173
  v_cvt_pk_bf16_f32 v183, v174, v175
  v_lshlrev_b32 v160, 16, v176
  v_and_b32 v161, 0xffff0000, v176
  v_lshlrev_b32 v162, 16, v177
  v_and_b32 v163, 0xffff0000, v177
  v_lshlrev_b32 v164, 16, v178
  v_and_b32 v165, 0xffff0000, v178
  v_lshlrev_b32 v166, 16, v179
  v_and_b32 v167, 0xffff0000, v179
  v_lshlrev_b32 v168, 16, v180
  v_and_b32 v169, 0xffff0000, v180
  v_lshlrev_b32 v170, 16, v181
  v_and_b32 v171, 0xffff0000, v181
  v_lshlrev_b32 v172, 16, v182
  v_and_b32 v173, 0xffff0000, v182
  v_lshlrev_b32 v174, 16, v183
  v_and_b32 v175, 0xffff0000, v183
  v_add_f32 v160, v160, v168
  v_add_f32 v161, v161, v169
  v_add_f32 v162, v162, v170
  v_add_f32 v163, v163, v171
  v_add_f32 v164, v164, v172
  v_add_f32 v165, v165, v173
  v_add_f32 v166, v166, v174
  v_add_f32 v167, v167, v175
  v_add_f32 v160, v160, v164
  v_add_f32 v161, v161, v165
  v_add_f32 v162, v162, v166
  v_add_f32 v163, v163, v167
  v_add_f32 v160, v160, v162
  v_add_f32 v161, v161, v163
  v_add_f32 v10, v160, v161
  v_mov_b32 v11, v10
  s_nop 1
  v_permlane32_swap_b32 v10, v11
  v_add_f32 v10, v10, v11
  v_mov_b32 v11, v10
  s_nop 1
  v_permlane16_swap_b32 v10, v11
  v_add_f32 v10, v10, v11
  s_lshl_b32 s4, s78, 2
  v_lshlrev_b32 v11, 5, v3
  v_add_u32 v11, s4, v11
  s_mov_b32 exec_lo, 0xf
  s_mov_b32 exec_hi, 0
  ds_write_b32 v11, v9 offset:28544
  ds_write_b32 v11, v10 offset:28672
  s_mov_b64 exec, 1
  v_mov_b32 v9, 0
  v_mov_b32 v10, 1
  s_waitcnt lgkmcnt(0)
  ds_add_u32 v9, v10 offset:16
  s_mov_b64 exec, -1
  s_mov_b32 s80, 0x05040100
  s_mov_b32 s81, 0x07060302
  s_mul_i32 s4, s78, 2304
  v_mul_u32_u24 v11, 576, v3
  v_lshl_add_u32 v11, v2, 4, v11
  v_add_u32 v11, s4, v11
  v_perm_b32 v16, v84, v80, s80
  v_perm_b32 v20, v84, v80, s81
  v_perm_b32 v24, v85, v81, s80
  v_perm_b32 v28, v85, v81, s81
  v_perm_b32 v32, v86, v82, s80
  v_perm_b32 v36, v86, v82, s81
  v_perm_b32 v40, v87, v83, s80
  v_perm_b32 v44, v87, v83, s81
  v_perm_b32 v17, v92, v88, s80
  v_perm_b32 v21, v92, v88, s81
  v_perm_b32 v25, v93, v89, s80
  v_perm_b32 v29, v93, v89, s81
  v_perm_b32 v33, v94, v90, s80
  v_perm_b32 v37, v94, v90, s81
  v_perm_b32 v41, v95, v91, s80
  v_perm_b32 v45, v95, v91, s81
  v_perm_b32 v18, v100, v96, s80
  v_perm_b32 v22, v100, v96, s81
  v_perm_b32 v26, v101, v97, s80
  v_perm_b32 v30, v101, v97, s81
  v_perm_b32 v34, v102, v98, s80
  v_perm_b32 v38, v102, v98, s81
  v_perm_b32 v42, v103, v99, s80
  v_perm_b32 v46, v103, v99, s81
  v_perm_b32 v19, v108, v104, s80
  v_perm_b32 v23, v108, v104, s81
  v_perm_b32 v27, v109, v105, s80
  v_perm_b32 v31, v109, v105, s81
  v_perm_b32 v35, v110, v106, s80
  v_perm_b32 v39, v110, v106, s81
  v_perm_b32 v43, v111, v107, s80
  v_perm_b32 v47, v111, v107, s81
  v_mfma_f32_16x16x32_bf16 v[48:51], v[16:19], v[176:179], 0
  v_mfma_f32_16x16x32_bf16 v[52:55], v[20:23], v[176:179], 0
  v_mfma_f32_16x16x32_bf16 v[56:59], v[24:27], v[176:179], 0
  v_mfma_f32_16x16x32_bf16 v[60:63], v[28:31], v[176:179], 0
  v_mfma_f32_16x16x32_bf16 v[64:67], v[32:35], v[176:179], 0
  v_mfma_f32_16x16x32_bf16 v[68:71], v[36:39], v[176:179], 0
  v_mfma_f32_16x16x32_bf16 v[72:75], v[40:43], v[176:179], 0
  v_mfma_f32_16x16x32_bf16 v[76:79], v[44:47], v[176:179], 0
  v_perm_b32 v16, v116, v112, s80
  v_perm_b32 v20, v116, v112, s81
  v_perm_b32 v24, v117, v113, s80
  v_perm_b32 v28, v117, v113, s81
  v_perm_b32 v32, v118, v114, s80
  v_perm_b32 v36, v118, v114, s81
  v_perm_b32 v40, v119, v115, s80
  v_perm_b32 v44, v119, v115, s81
  v_perm_b32 v17, v124, v120, s80
  v_perm_b32 v21, v124, v120, s81
  v_perm_b32 v25, v125, v121, s80
  v_perm_b32 v29, v125, v121, s81
  v_perm_b32 v33, v126, v122, s80
  v_perm_b32 v37, v126, v122, s81
  v_perm_b32 v41, v127, v123, s80
  v_perm_b32 v45, v127, v123, s81
  v_perm_b32 v18, v132, v128, s80
  v_perm_b32 v22, v132, v128, s81
  v_perm_b32 v26, v133, v129, s80
  v_perm_b32 v30, v133, v129, s81
  v_perm_b32 v34, v134, v130, s80
  v_perm_b32 v38, v134, v130, s81
  v_perm_b32 v42, v135, v131, s80
  v_perm_b32 v46, v135, v131, s81
  v_perm_b32 v19, v140, v136, s80
  v_perm_b32 v23, v140, v136, s81
  v_perm_b32 v27, v141, v137, s80
  v_perm_b32 v31, v141, v137, s81
  v_perm_b32 v35, v142, v138, s80
  v_perm_b32 v39, v142, v138, s81
  v_perm_b32 v43, v143, v139, s80
  v_perm_b32 v47, v143, v139, s81
  v_mfma_f32_16x16x32_bf16 v[48:51], v[16:19], v[180:183], v[48:51]
  v_mfma_f32_16x16x32_bf16 v[52:55], v[20:23], v[180:183], v[52:55]
  v_mfma_f32_16x16x32_bf16 v[56:59], v[24:27], v[180:183], v[56:59]
  v_mfma_f32_16x16x32_bf16 v[60:63], v[28:31], v[180:183], v[60:63]
  v_mfma_f32_16x16x32_bf16 v[64:67], v[32:35], v[180:183], v[64:67]
  v_mfma_f32_16x16x32_bf16 v[68:71], v[36:39], v[180:183], v[68:71]
  v_mfma_f32_16x16x32_bf16 v[72:75], v[40:43], v[180:183], v[72:75]
  v_mfma_f32_16x16x32_bf16 v[76:79], v[44:47], v[180:183], v[76:79]
  s_mov_b32 exec_lo, 0x000f000f
  s_mov_b32 exec_hi, 0x000f000f
  ds_write_b128 v11, v[48:51] offset:10112
  ds_write_b128 v11, v[52:55] offset:10176
  ds_write_b128 v11, v[56:59] offset:10240
  ds_write_b128 v11, v[60:63] offset:10304
  ds_write_b128 v11, v[64:67] offset:10368
  ds_write_b128 v11, v[68:71] offset:10432
  ds_write_b128 v11, v[72:75] offset:10496
  ds_write_b128 v11, v[76:79] offset:10560
  s_mov_b64 exec, -1
  s_branch L_pvdone
L_flowE:
  s_mov_b32 s83, 0
  v_mov_b32 v9, 0
L_qflag_25:
  ds_read_b32 v10, v9 offset:0
  s_waitcnt lgkmcnt(0)
  v_cmp_ne_u32 vcc, 1, v10
  s_cbranch_vccz L_ok_26
  s_add_u32 s83, s83, 1
  s_cmp_lt_u32 s83, 1600000
  s_cbranch_scc0 L_ok_26
  s_sleep 1
  s_branch L_qflag_25
L_ok_26:
  v_and_b32 v9, 3, v3
  v_mul_u32_u24 v9, 320, v9
  v_lshl_add_u32 v9, v2, 4, v9
  ds_read_b128 v[144:147], v9 offset:64
  ds_read_b128 v[148:151], v9 offset:128
  ds_read_b128 v[152:155], v9 offset:192
  ds_read_b128 v[156:159], v9 offset:256
  s_waitcnt lgkmcnt(0)
  v_mfma_f32_16x16x32_bf16 v[160:163], v[16:19], v[144:147], 0
  v_mfma_f32_16x16x32_bf16 v[232:235], v[16:19], v[148:151], 0
  v_mfma_f32_16x16x32_bf16 v[236:239], v[24:27], v[144:147], 0
  v_mfma_f32_16x16x32_bf16 v[240:243], v[24:27], v[148:151], 0
  v_mfma_f32_16x16x32_bf16 v[160:163], v[20:23], v[152:155], v[160:163]
  v_mfma_f32_16x16x32_bf16 v[232:235], v[20:23], v[156:159], v[232:235]
  v_mfma_f32_16x16x32_bf16 v[236:239], v[28:31], v[152:155], v[236:239]
  v_mfma_f32_16x16x32_bf16 v[240:243], v[28:31], v[156:159], v[240:243]
  v_mfma_f32_16x16x32_bf16 v[164:167], v[32:35], v[144:147], 0
  v_mfma_f32_16x16x32_bf16 v[244:247], v[32:35], v[148:151], 0
  v_mfma_f32_16x16x32_bf16 v[248:251], v[40:43], v[144:147], 0
  v_mfma_f32_16x16x32_bf16 v[252:255], v[40:43], v[148:151], 0
  v_mfma_f32_16x16x32_bf16 v[164:167], v[36:39], v[152:155], v[164:167]
  v_mfma_f32_16x16x32_bf16 v[244:247], v[36:39], v[156:159], v[244:247]
  v_mfma_f32_16x16x32_bf16 v[248:251], v[44:47], v[152:155], v[248:251]
  v_mfma_f32_16x16x32_bf16 v[252:255], v[44:47], v[156:159], v[252:255]
  v_permlane32_swap_b32 v160, v236
  v_permlane32_swap_b32 v232, v240
  v_permlane32_swap_b32 v161, v237
  v_permlane32_swap_b32 v233, v241
  v_permlane32_swap_b32 v162, v238
  v_permlane32_swap_b32 v234, v242
  v_permlane32_swap_b32 v163, v239
  v_permlane32_swap_b32 v235, v243
  v_add_f32 v160, v160, v240
  v_add_f32 v161, v161, v241
  v_add_f32 v162, v162, v242
  v_add_f32 v163, v163, v243
  v_mfma_f32_16x16x32_bf16 v[168:171], v[48:51], v[144:147], 0
  v_mfma_f32_16x16x32_bf16 v[232:235], v[48:51], v[148:151], 0
  v_mfma_f32_16x16x32_bf16 v[236:239], v[56:59], v[144:147], 0
  v_mfma_f32_16x16x32_bf16 v[240:243], v[56:59], v[148:151], 0
  v_mfma_f32_16x16x32_bf16 v[168:171], v[52:55], v[152:155], v[168:171]
  v_mfma_f32_16x16x32_bf16 v[232:235], v[52:55], v[156:159], v[232:235]
  v_mfma_f32_16x16x32_bf16 v[236:239], v[60:63], v[152:155], v[236:239]
  v_mfma_f32_16x16x32_bf16 v[240:243], v[60:63], v[156:159], v[240:243]
  v_permlane32_swap_b32 v164, v248
  v_permlane32_swap_b32 v244, v252
  v_permlane32_swap_b32 v165, v249
  v_permlane32_swap_b32 v245, v253
  v_permlane32_swap_b32 v166, v250
  v_permlane32_swap_b32 v246, v254
  v_permlane32_swap_b32 v167, v251
  v_permlane32_swap_b32 v247, v255
  v_add_f32 v164, v164, v252
  v_add_f32 v165, v165, v253
  v_add_f32 v166, v166, v254
  v_add_f32 v167, v167, v255
  v_mfma_f32_16x16x32_bf16 v[172:175], v[64:67], v[144:147], 0
  v_mfma_f32_16x16x32_bf16 v[244:247], v[64:67], v[148:151], 0
  v_mfma_f32_16x16x32_bf16 v[248:251], v[72:75], v[144:147], 0
  v_mfma_f32_16x16x32_bf16 v[252:255], v[72:75], v[148:151], 0
  v_mfma_f32_16x16x32_bf16 v[172:175], v[68:71], v[152:155], v[172:175]
  v_mfma_f32_16x16x32_bf16 v[244:247], v[68:71], v[156:159], v[244:247]
  v_mfma_f32_16x16x32_bf16 v[248:251], v[76:79], v[152:155], v[248:251]
  v_mfma_f32_16x16x32_bf16 v[252:255], v[76:79], v[156:159], v[252:255]
  v_permlane32_swap_b32 v168, v236
  v_permlane32_swap_b32 v232, v240
  v_permlane32_swap_b32 v169, v237
  v_permlane32_swap_b32 v233, v241
  v_permlane32_swap_b32 v170, v238
  v_permlane32_swap_b32 v234, v242
  v_permlane32_swap_b32 v171, v239
  v_permlane32_swap_b32 v235, v243
  v_add_f32 v168, v168, v240
  v_add_f32 v169, v169, v241
  v_add_f32 v170, v170, v242
  v_add_f32 v171, v171, v243
  v_permlane32_swap_b32 v172, v248
  v_permlane32_swap_b32 v244, v252
  v_permlane32_swap_b32 v173, v249
  v_permlane32_swap_b32 v245, v253
  v_permlane32_swap_b32 v174, v250
  v_permlane32_swap_b32 v246, v254
  v_permlane32_swap_b32 v175, v251
  v_permlane32_swap_b32 v247, v255
  v_add_f32 v172, v172, v252
  v_add_f32 v173, v173, v253
  v_add_f32 v174, v174, v254
  v_add_f32 v175, v175, v255
  s_mov_b32 s4, 0x3db504f3
  v_cvt_pk_bf16_f32 v161, v160, v161
  v_lshlrev_b32 v160, 16, v161
  v_and_b32 v161, 0xffff0000, v161
  v_mul_f32 v160, s4, v160
  v_mul_f32 v161, s4, v161
  v_cvt_pk_bf16_f32 v161, v160, v161
  v_lshlrev_b32 v160, 16, v161
  v_and_b32 v161, 0xffff0000, v161
  v_cvt_pk_bf16_f32 v163, v162, v163
  v_lshlrev_b32 v162, 16, v163
  v_and_b32 v163, 0xffff0000, v163
  v_mul_f32 v162, s4, v162
  v_mul_f32 v163, s4, v163
  v_cvt_pk_bf16_f32 v163, v162, v163
  v_lshlrev_b32 v162, 16, v163
  v_and_b32 v163, 0xffff0000, v163
  v_cvt_pk_bf16_f32 v165, v164, v165
  v_lshlrev_b32 v164, 16, v165
  v_and_b32 v165, 0xffff0000, v165
  v_mul_f32 v164, s4, v164
  v_mul_f32 v165, s4, v165
  v_cvt_pk_bf16_f32 v165, v164, v165
  v_lshlrev_b32 v164, 16, v165
  v_and_b32 v165, 0xffff0000, v165
  v_cvt_pk_bf16_f32 v167, v166, v167
  v_lshlrev_b32 v166, 16, v167
  v_and_b32 v167, 0xffff0000, v167
  v_mul_f32 v166, s4, v166
  v_mul_f32 v167, s4, v167
  v_cvt_pk_bf16_f32 v167, v166, v167
  v_lshlrev_b32 v166, 16, v167
  v_and_b32 v167, 0xffff0000, v167
  v_cvt_pk_bf16_f32 v169, v168, v169
  v_lshlrev_b32 v168, 16, v169
  v_and_b32 v169, 0xffff0000, v169
  v_mul_f32 v168, s4, v168
  v_mul_f32 v169, s4, v169
  v_cvt_pk_bf16_f32 v169, v168, v169
  v_lshlrev_b32 v168, 16, v169
  v_and_b32 v169, 0xffff0000, v169
  v_cvt_pk_bf16_f32 v171, v170, v171
  v_lshlrev_b32 v170, 16, v171
  v_and_b32 v171, 0xffff0000, v171
  v_mul_f32 v170, s4, v170
  v_mul_f32 v171, s4, v171
  v_cvt_pk_bf16_f32 v171, v170, v171
  v_lshlrev_b32 v170, 16, v171
  v_and_b32 v171, 0xffff0000, v171
  v_cvt_pk_bf16_f32 v173, v172, v173
  v_lshlrev_b32 v172, 16, v173
  v_and_b32 v173, 0xffff0000, v173
  v_mul_f32 v172, s4, v172
  v_mul_f32 v173, s4, v173
  v_cvt_pk_bf16_f32 v173, v172, v173
  v_lshlrev_b32 v172, 16, v173
  v_and_b32 v173, 0xffff0000, v173
  v_cvt_pk_bf16_f32 v175, v174, v175
  v_lshlrev_b32 v174, 16, v175
  v_and_b32 v175, 0xffff0000, v175
  v_mul_f32 v174, s4, v174
  v_mul_f32 v175, s4, v175
  v_cvt_pk_bf16_f32 v175, v174, v175
  v_lshlrev_b32 v174, 16, v175
  v_and_b32 v175, 0xffff0000, v175
  v_max3_f32 v9, v160, v161, v162
  v_max3_f32 v9, v9, v163, v164
  v_max3_f32 v9, v9, v165, v166
  v_max3_f32 v9, v9, v167, v168
  v_max3_f32 v9, v9, v169, v170
  v_max3_f32 v9, v9, v171, v172
  v_max3_f32 v9, v9, v173, v174
  v_max_f32 v9, v9, v175
  v_mov_b32 v10, v9
  s_nop 1
  v_permlane32_swap_b32 v9, v10
  v_max_f32 v9, v9, v10
  v_mov_b32 v10, v9
  s_nop 1
  v_permlane16_swap_b32 v9, v10
  v_max_f32 v9, v9, v10
  s_mov_b32 s4, 0x3fb8aa3b
  v_mul_f32 v9, s4, v9
  v_bfi_b32 v9, v8, 0, v9
  v_fma_f32 v160, v160, s4, -v9
  v_fma_f32 v161, v161, s4, -v9
  v_fma_f32 v162, v162, s4, -v9
  v_fma_f32 v163, v163, s4, -v9
  v_fma_f32 v164, v164, s4, -v9
  v_fma_f32 v165, v165, s4, -v9
  v_fma_f32 v166, v166, s4, -v9
  v_fma_f32 v167, v167, s4, -v9
  v_fma_f32 v168, v168, s4, -v9
  v_fma_f32 v169, v169, s4, -v9
  v_fma_f32 v170, v170, s4, -v9
  v_fma_f32 v171, v171, s4, -v9
  v_fma_f32 v172, v172, s4, -v9
  v_fma_f32 v173, v173, s4, -v9
  v_fma_f32 v174, v174, s4, -v9
  v_fma_f32 v175, v175, s4, -v9
  v_exp_f32 v160, v160
  v_exp_f32 v161, v161
  v_exp_f32 v162, v162
  v_exp_f32 v163, v163
  v_exp_f32 v164, v164
  v_exp_f32 v165, v165
  v_exp_f32 v166, v166
  v_exp_f32 v167, v167
  v_exp_f32 v168, v168
  v_exp_f32 v169, v169
  v_exp_f32 v170, v170
  v_exp_f32 v171, v171
  v_exp_f32 v172, v172
  v_exp_f32 v173, v173
  v_exp_f32 v174, v174
  v_exp_f32 v175, v175
  v_cvt_pk_bf16_f32 v176, v160, v161
  v_cvt_pk_bf16_f32 v177, v162, v163
  v_cvt_pk_bf16_f32 v178, v164, v165
  v_cvt_pk_bf16_f32 v179, v166, v167
  v_cvt_pk_bf16_f32 v180, v168, v169
  v_cvt_pk_bf16_f32 v181, v170, v171
  v_cvt_pk_bf16_f32 v182, v172, v173
  v_cvt_pk_bf16_f32 v183, v174, v175
  v_lshlrev_b32 v160, 16, v176
  v_and_b32 v161, 0xffff0000, v176
  v_lshlrev_b32 v162, 16, v177
  v_and_b32 v163, 0xffff0000, v177
  v_lshlrev_b32 v164, 16, v178
  v_and_b32 v165, 0xffff0000, v178
  v_lshlrev_b32 v166, 16, v179
  v_and_b32 v167, 0xffff0000, v179
  v_lshlrev_b32 v168, 16, v180
  v_and_b32 v169, 0xffff0000, v180
  v_lshlrev_b32 v170, 16, v181
  v_and_b32 v171, 0xffff0000, v181
  v_lshlrev_b32 v172, 16, v182
  v_and_b32 v173, 0xffff0000, v182
  v_lshlrev_b32 v174, 16, v183
  v_and_b32 v175, 0xffff0000, v183
  v_add_f32 v160, v160, v168
  v_add_f32 v161, v161, v169
  v_add_f32 v162, v162, v170
  v_add_f32 v163, v163, v171
  v_add_f32 v164, v164, v172
  v_add_f32 v165, v165, v173
  v_add_f32 v166, v166, v174
  v_add_f32 v167, v167, v175
  v_add_f32 v160, v160, v164
  v_add_f32 v161, v161, v165
  v_add_f32 v162, v162, v166
  v_add_f32 v163, v163, v167
  v_add_f32 v160, v160, v162
  v_add_f32 v161, v161, v163
  v_add_f32 v10, v160, v161
  v_mov_b32 v11, v10
  s_nop 1
  v_permlane32_swap_b32 v10, v11
  v_add_f32 v10, v10, v11
  v_mov_b32 v11, v10
  s_nop 1
  v_permlane16_swap_b32 v10, v11
  v_add_f32 v10, v10, v11
  s_lshl_b32 s4, s78, 2
  v_lshlrev_b32 v11, 5, v3
  v_add_u32 v11, s4, v11
  s_mov_b32 exec_lo, 0xf
  s_mov_b32 exec_hi, 0
  ds_write_b32 v11, v9 offset:28544
  ds_write_b32 v11, v10 offset:28672
  s_mov_b64 exec, 1
  v_mov_b32 v9, 0
  v_mov_b32 v10, 1
  s_waitcnt lgkmcnt(0)
  ds_add_u32 v9, v10 offset:16
  s_mov_b64 exec, -1
  s_add_i32 s4, s101, 0
  s_mov_b32 s83, 0
  v_mov_b32 v9, 0
L_gate_27:
  ds_read_b32 v10, v9 offset:8
  s_waitcnt lgkmcnt(0)
  v_readfirstlane_b32 s5, v10
  s_cmp_ge_i32 s5, s4
  s_cbranch_scc1 L_gok_28
  s_add_u32 s83, s83, 1
  s_cmp_lt_u32 s83, 1600000
  s_cbranch_scc0 L_gok_28
  s_sleep 1
  s_branch L_gate_27
L_gok_28:
  buffer_load_dwordx4 v[80:83], v5, s[44:47], 0 offen offset:0 nt
  buffer_load_dwordx4 v[84:87], v5, s[44:47], 0 offen offset:1024 nt
  buffer_load_dwordx4 v[88:91], v5, s[44:47], 0 offen offset:2048 nt
  buffer_load_dwordx4 v[92:95], v5, s[44:47], 0 offen offset:3072 nt
  buffer_load_dwordx4 v[96:99], v5, s[44:47], s9 offen offset:0 nt
  buffer_load_dwordx4 v[100:103], v5, s[44:47], s9 offen offset:1024 nt
  buffer_load_dwordx4 v[104:107], v5, s[44:47], s9 offen offset:2048 nt
  buffer_load_dwordx4 v[108:111], v5, s[44:47], s9 offen offset:3072 nt
  s_add_i32 s4, s101, 1
  s_mov_b32 s83, 0
  v_mov_b32 v9, 0
L_gate_29:
  ds_read_b32 v10, v9 offset:8
  s_waitcnt lgkmcnt(0)
  v_readfirstlane_b32 s5, v10
  s_cmp_ge_i32 s5, s4
  s_cbranch_scc1 L_gok_30
  s_add_u32 s83, s83, 1
  s_cmp_lt_u32 s83, 1600000
  s_cbranch_scc0 L_gok_30
  s_sleep 1
  s_branch L_gate_29
L_gok_30:
  buffer_load_dwordx4 v[112:115], v5, s[44:47], s10 offen offset:0 nt
  buffer_load_dwordx4 v[116:119], v5, s[44:47], s10 offen offset:1024 nt
  buffer_load_dwordx4 v[120:123], v5, s[44:47], s10 offen offset:2048 nt
  buffer_load_dwordx4 v[124:127], v5, s[44:47], s10 offen offset:3072 nt
  buffer_load_dwordx4 v[128:131], v5, s[44:47], s11 offen offset:0 nt
  buffer_load_dwordx4 v[132:135], v5, s[44:47], s11 offen offset:1024 nt
  buffer_load_dwordx4 v[136:139], v5, s[44:47], s11 offen offset:2048 nt
  buffer_load_dwordx4 v[140:143], v5, s[44:47], s11 offen offset:3072 nt
  s_cmp_eq_u32 s78, 1
  s_cbranch_scc0 L_now1
  s_mov_b32 s52, s24
  s_mov_b32 s53, s25
  s_mov_b32 s54, 4194304
  s_mov_b32 s55, 0x20000
  s_mov_b32 s56, s32
  s_mov_b32 s57, s33
  s_mov_b32 s58, 1835008
  s_mov_b32 s59, 0x20000
  s_and_b32 s4, s75, 3
  s_lshl_b32 s5, s74, 2
  s_add_u32 s4, s4, s5
  s_lshl_b32 s7, s4, 1
  s_bfe_u32 s5, s75, 0x10002
  s_add_u32 s7, s7, s5
  s_lshl_b32 s4, s4, 7
  s_lshl_b32 s5, s5, 2
  s_add_u32 s4, s4, s5
  s_lshl_b32 s4, s4, 10
  s_lshr_b32 s5, s75, 3
  s_lshl_b32 s5, s5, 8
  s_lshl_b32 s6, s78, 7
  s_add_u32 s5, s5, s6
  s_add_u32 s4, s4, s5
  v_and_b32 v12, 1, v2
  v_lshlrev_b32 v12, 6, v12
  v_lshrrev_b32 v13, 1, v2
  v_add_u32 v14, v12, v13
  v_lshlrev_b32 v14, 10, v14
  v_lshl_add_u32 v14, v3, 3, v14
  v_add_u32 v252, s4, v14
  s_lshr_b32 s4, s7, 2
  s_lshl_b32 s4, s4, 7
  s_and_b32 s6, s7, 3
  s_lshl_b32 s6, s6, 3
  s_add_u32 s4, s4, s6
  s_lshl_b32 s4, s4, 10
  s_add_u32 s4, s4, s5
  v_lshl_add_u32 v15, v13, 2, v12
  v_lshlrev_b32 v15, 10, v15
  v_lshl_add_u32 v15, v3, 3, v15
  v_add_u32 v253, s4, v15
  s_mov_b32 s3, 32768
  s_mov_b32 s82, 8192
  s_mov_b32 s6, 0
  buffer_load_dwordx2 v[184:185], v252, s[52:55], s6 offen offset:0 nt
  buffer_load_dwordx2 v[200:201], v252, s[52:55], s6 offen offset:2048 nt
  s_add_u32 s6, s6, 8192
  buffer_load_dwordx2 v[186:187], v252, s[52:55], s6 offen offset:0 nt
  buffer_load_dwordx2 v[202:203], v252, s[52:55], s6 offen offset:2048 nt
  s_add_u32 s6, s6, 8192
  buffer_load_dwordx2 v[188:189], v252, s[52:55], s6 offen offset:0 nt
  buffer_load_dwordx2 v[204:205], v252, s[52:55], s6 offen offset:2048 nt
  s_add_u32 s6, s6, 8192
  buffer_load_dwordx2 v[190:191], v252, s[52:55], s6 offen offset:0 nt
  buffer_load_dwordx2 v[206:207], v252, s[52:55], s6 offen offset:2048 nt
  s_add_u32 s6, s6, 8192
  buffer_load_dwordx2 v[192:193], v252, s[52:55], s6 offen offset:0 nt
  buffer_load_dwordx2 v[208:209], v252, s[52:55], s6 offen offset:2048 nt
  s_add_u32 s6, s6, 8192
  buffer_load_dwordx2 v[194:195], v252, s[52:55], s6 offen offset:0 nt
  buffer_load_dwordx2 v[210:211], v252, s[52:55], s6 offen offset:2048 nt
  s_add_u32 s6, s6, 8192
  buffer_load_dwordx2 v[196:197], v252, s[52:55], s6 offen offset:0 nt
  buffer_load_dwordx2 v[212:213], v252, s[52:55], s6 offen offset:2048 nt
  s_add_u32 s6, s6, 8192
  buffer_load_dwordx2 v[198:199], v252, s[52:55], s6 offen offset:0 nt
  buffer_load_dwordx2 v[214:215], v252, s[52:55], s6 offen offset:2048 nt
  buffer_load_dwordx2 v[216:217], v253, s[56:59], 0 offen offset:0 nt
  buffer_load_dwordx2 v[218:219], v253, s[56:59], 0 offen offset:1024 nt
  buffer_load_dwordx2 v[220:221], v253, s[56:59], 0 offen offset:2048 nt
  buffer_load_dwordx2 v[222:223], v253, s[56:59], 0 offen offset:3072 nt
  buffer_load_dwordx2 v[224:225], v253, s[56:59], s3 offen offset:0 nt
  buffer_load_dwordx2 v[226:227], v253, s[56:59], s3 offen offset:1024 nt
  buffer_load_dwordx2 v[228:229], v253, s[56:59], s3 offen offset:2048 nt
  buffer_load_dwordx2 v[230:231], v253, s[56:59], s3 offen offset:3072 nt
L_now1:
  s_mov_b32 s83, 0
  v_mov_b32 v12, 0
L_mc_31:
  ds_read_b32 v13, v12 offset:16
  s_waitcnt lgkmcnt(0)
  v_cmp_gt_u32 vcc, 8, v13
  s_cbranch_vccz L_mcok_32
  s_add_u32 s83, s83, 1
  s_cmp_lt_u32 s83, 1600000
  s_cbranch_scc0 L_mcok_32
  s_sleep 1
  s_branch L_mc_31
L_mcok_32:
  s_lshl_b32 s4, s78, 6
  v_add_u32 v13, s4, v1
  v_lshrrev_b32 v14, 5, v13
  v_and_b32 v15, 31, v13
  v_lshlrev_b32 v13, 5, v14
  ds_read_b128 v[164:167], v13 offset:28544
  ds_read_b128 v[168:171], v13 offset:28560
  ds_read_b128 v[232:235], v13 offset:28672
  ds_read_b128 v[236:239], v13 offset:28688
  ds_read_b32 v172, v12 offset:4
  v_mul_u32_u24 v156, 576, v14
  v_lshl_add_u32 v156, v15, 4, v156
  s_lshl_b32 s4, s74, 16
  s_lshl_b32 s5, s76, 11
  s_add_u32 s4, s4, s5
  s_lshl_b32 s5, s77, 8
  s_add_u32 s4, s4, s5
  s_add_u32 s4, s4, 1572864
  v_lshlrev_b32 v157, 14, v14
  v_lshrrev_b32 v13, 4, v15
  v_lshl_add_u32 v157, v13, 13, v157
  v_and_b32 v13, 15, v15
  v_lshl_add_u32 v157, v13, 4, v157
  v_add_u32 v157, s4, v157
  s_lshl_b32 s4, s74, 11
  s_lshl_b32 s5, s76, 7
  s_add_u32 s4, s4, s5
  s_lshl_b32 s5, s77, 4
  s_add_u32 s4, s4, s5
  s_add_u32 s4, s4, 2097152
  v_lshlrev_b32 v158, 9, v14
  v_add_u32 v158, s4, v158
  s_and_b32 s4, s75, 3
  s_lshl_b32 s5, s74, 2
  s_add_u32 s4, s4, s5
  s_lshl_b32 s7, s4, 1
  s_bfe_u32 s5, s75, 0x10002
  s_add_u32 s7, s7, s5
  s_lshl_b32 s6, s4, 9
  s_lshl_b32 s4, s7, 13
  s_add_u32 s4, s4, 1572864
  s_add_u32 s6, s6, 2097152
  s_lshl_b32 s5, s78, 12
  s_add_u32 s4, s4, s5
  s_lshl_b32 s5, s78, 8
  s_add_u32 s6, s6, s5
  v_lshlrev_b32 v159, 10, v2
  v_lshl_add_u32 v159, v3, 4, v159
  v_add_u32 v159, s4, v159
  v_and_b32 v13, 1, v2
  v_lshl_add_u32 v160, v13, 2, v3
  v_and_b32 v160, 7, v160
  v_lshlrev_b32 v160, 4, v160
  v_lshrrev_b32 v13, 1, v2
  v_lshl_add_u32 v160, v13, 7, v160
  v_add_u32 v160, s6, v160
  v_cmp_eq_u32 s[90:91], 0, v15
  s_waitcnt lgkmcnt(0)
  v_readfirstlane_b32 s79, v172
  v_max3_f32 v173, v164, v165, v166
  v_max3_f32 v173, v173, v167, v168
  v_max3_f32 v173, v173, v169, v170
  v_max_f32 v173, v173, v171
  v_sub_f32 v144, v164, v173
  v_sub_f32 v145, v165, v173
  v_sub_f32 v146, v166, v173
  v_sub_f32 v147, v167, v173
  v_sub_f32 v148, v168, v173
  v_sub_f32 v149, v169, v173
  v_sub_f32 v150, v170, v173
  v_sub_f32 v151, v171, v173
  v_exp_f32 v144, v144
  v_exp_f32 v145, v145
  v_exp_f32 v146, v146
  v_exp_f32 v147, v147
  v_exp_f32 v148, v148
  v_exp_f32 v149, v149
  v_exp_f32 v150, v150
  v_exp_f32 v151, v151
  v_mul_f32 v174, v144, v232
  v_fmac_f32 v174, v145, v233
  v_fmac_f32 v174, v146, v234
  v_fmac_f32 v174, v147, v235
  v_fmac_f32 v174, v148, v236
  v_fmac_f32 v174, v149, v237
  v_fmac_f32 v174, v150, v238
  v_fmac_f32 v174, v151, v239
  v_bfi_b32 v152, v8, s68, v173
  v_bfi_b32 v153, v8, s69, v174
  v_mov_b32 v154, s70
  v_mov_b32 v155, s71
  s_mov_b32 s80, 0x05040100
  s_mov_b32 s81, 0x07060302
  s_mul_i32 s4, s78, 2304
  v_mul_u32_u24 v11, 576, v3
  v_lshl_add_u32 v11, v2, 4, v11
  v_add_u32 v11, s4, v11
  s_cmp_eq_u32 s78, 1
  s_cbranch_scc1 L_w7_33
  s_waitcnt vmcnt(8)
  s_branch L_wd_34
L_w7_33:
  s_waitcnt vmcnt(32)
L_wd_34:
  s_cmp_eq_u32 s78, 0
  s_cbranch_scc0 L_w0w_35
  s_mov_b32 s52, s24
  s_mov_b32 s53, s25
  s_mov_b32 s54, 4194304
  s_mov_b32 s55, 0x20000
  s_mov_b32 s56, s32
  s_mov_b32 s57, s33
  s_mov_b32 s58, 1835008
  s_mov_b32 s59, 0x20000
  s_and_b32 s4, s75, 3
  s_lshl_b32 s5, s74, 2
  s_add_u32 s4, s4, s5
  s_lshl_b32 s7, s4, 1
  s_bfe_u32 s5, s75, 0x10002
  s_add_u32 s7, s7, s5
  s_lshl_b32 s4, s4, 7
  s_lshl_b32 s5, s5, 2
  s_add_u32 s4, s4, s5
  s_lshl_b32 s4, s4, 10
  s_lshr_b32 s5, s75, 3
  s_lshl_b32 s5, s5, 8
  s_lshl_b32 s6, s78, 7
  s_add_u32 s5, s5, s6
  s_add_u32 s4, s4, s5
  v_and_b32 v12, 1, v2
  v_lshlrev_b32 v12, 6, v12
  v_lshrrev_b32 v13, 1, v2
  v_add_u32 v14, v12, v13
  v_lshlrev_b32 v14, 10, v14
  v_lshl_add_u32 v14, v3, 3, v14
  v_add_u32 v252, s4, v14
  s_lshr_b32 s4, s7, 2
  s_lshl_b32 s4, s4, 7
  s_and_b32 s6, s7, 3
  s_lshl_b32 s6, s6, 3
  s_add_u32 s4, s4, s6
  s_lshl_b32 s4, s4, 10
  s_add_u32 s4, s4, s5
  v_lshl_add_u32 v15, v13, 2, v12
  v_lshlrev_b32 v15, 10, v15
  v_lshl_add_u32 v15, v3, 3, v15
  v_add_u32 v253, s4, v15
  s_mov_b32 s3, 32768
  s_mov_b32 s82, 8192
  s_mov_b32 s6, 0
  buffer_load_dwordx2 v[184:185], v252, s[52:55], s6 offen offset:0 nt
  buffer_load_dwordx2 v[200:201], v252, s[52:55], s6 offen offset:2048 nt
  s_add_u32 s6, s6, 8192
  buffer_load_dwordx2 v[186:187], v252, s[52:55], s6 offen offset:0 nt
  buffer_load_dwordx2 v[202:203], v252, s[52:55], s6 offen offset:2048 nt
  s_add_u32 s6, s6, 8192
  buffer_load_dwordx2 v[188:189], v252, s[52:55], s6 offen offset:0 nt
  buffer_load_dwordx2 v[204:205], v252, s[52:55], s6 offen offset:2048 nt
  s_add_u32 s6, s6, 8192
  buffer_load_dwordx2 v[190:191], v252, s[52:55], s6 offen offset:0 nt
  buffer_load_dwordx2 v[206:207], v252, s[52:55], s6 offen offset:2048 nt
  s_add_u32 s6, s6, 8192
  buffer_load_dwordx2 v[192:193], v252, s[52:55], s6 offen offset:0 nt
  buffer_load_dwordx2 v[208:209], v252, s[52:55], s6 offen offset:2048 nt
  s_add_u32 s6, s6, 8192
  buffer_load_dwordx2 v[194:195], v252, s[52:55], s6 offen offset:0 nt
  buffer_load_dwordx2 v[210:211], v252, s[52:55], s6 offen offset:2048 nt
  s_add_u32 s6, s6, 8192
  buffer_load_dwordx2 v[196:197], v252, s[52:55], s6 offen offset:0 nt
  buffer_load_dwordx2 v[212:213], v252, s[52:55], s6 offen offset:2048 nt
  s_add_u32 s6, s6, 8192
  buffer_load_dwordx2 v[198:199], v252, s[52:55], s6 offen offset:0 nt
  buffer_load_dwordx2 v[214:215], v252, s[52:55], s6 offen offset:2048 nt
  buffer_load_dwordx2 v[216:217], v253, s[56:59], 0 offen offset:0 nt
  buffer_load_dwordx2 v[218:219], v253, s[56:59], 0 offen offset:1024 nt
  buffer_load_dwordx2 v[220:221], v253, s[56:59], 0 offen offset:2048 nt
  buffer_load_dwordx2 v[222:223], v253, s[56:59], 0 offen offset:3072 nt
  buffer_load_dwordx2 v[224:225], v253, s[56:59], s3 offen offset:0 nt
  buffer_load_dwordx2 v[226:227], v253, s[56:59], s3 offen offset:1024 nt
  buffer_load_dwordx2 v[228:229], v253, s[56:59], s3 offen offset:2048 nt
  buffer_load_dwordx2 v[230:231], v253, s[56:59], s3 offen offset:3072 nt
L_w0w_35:
  v_perm_b32 v16, v84, v80, s80
  v_perm_b32 v20, v84, v80, s81
  v_perm_b32 v24, v85, v81, s80
  v_perm_b32 v28, v85, v81, s81
  v_perm_b32 v32, v86, v82, s80
  v_perm_b32 v36, v86, v82, s81
  v_perm_b32 v40, v87, v83, s80
  v_perm_b32 v44, v87, v83, s81
  v_perm_b32 v17, v92, v88, s80
  v_perm_b32 v21, v92, v88, s81
  v_perm_b32 v25, v93, v89, s80
  v_perm_b32 v29, v93, v89, s81
  v_perm_b32 v33, v94, v90, s80
  v_perm_b32 v37, v94, v90, s81
  v_perm_b32 v41, v95, v91, s80
  v_perm_b32 v45, v95, v91, s81
  v_perm_b32 v18, v100, v96, s80
  v_perm_b32 v22, v100, v96, s81
  v_perm_b32 v26, v101, v97, s80
  v_perm_b32 v30, v101, v97, s81
  v_perm_b32 v34, v102, v98, s80
  v_perm_b32 v38, v102, v98, s81
  v_perm_b32 v42, v103, v99, s80
  v_perm_b32 v46, v103, v99, s81
  v_perm_b32 v19, v108, v104, s80
  v_perm_b32 v23, v108, v104, s81
  v_perm_b32 v27, v109, v105, s80
  v_perm_b32 v31, v109, v105, s81
  v_perm_b32 v35, v110, v106, s80
  v_perm_b32 v39, v110, v106, s81
  v_perm_b32 v43, v111, v107, s80
  v_perm_b32 v47, v111, v107, s81
  v_mfma_f32_16x16x32_bf16 v[48:51], v[16:19], v[176:179], 0
  v_mfma_f32_16x16x32_bf16 v[52:55], v[20:23], v[176:179], 0
  v_mfma_f32_16x16x32_bf16 v[56:59], v[24:27], v[176:179], 0
  v_mfma_f32_16x16x32_bf16 v[60:63], v[28:31], v[176:179], 0
  v_mfma_f32_16x16x32_bf16 v[64:67], v[32:35], v[176:179], 0
  v_mfma_f32_16x16x32_bf16 v[68:71], v[36:39], v[176:179], 0
  v_mfma_f32_16x16x32_bf16 v[72:75], v[40:43], v[176:179], 0
  v_mfma_f32_16x16x32_bf16 v[76:79], v[44:47], v[176:179], 0
  s_waitcnt vmcnt(30)
  v_perm_b32 v16, v116, v112, s80
  v_perm_b32 v20, v116, v112, s81
  v_perm_b32 v24, v117, v113, s80
  v_perm_b32 v28, v117, v113, s81
  v_perm_b32 v32, v118, v114, s80
  v_perm_b32 v36, v118, v114, s81
  v_perm_b32 v40, v119, v115, s80
  v_perm_b32 v44, v119, v115, s81
  s_waitcnt vmcnt(28)
  v_perm_b32 v17, v124, v120, s80
  v_perm_b32 v21, v124, v120, s81
  v_perm_b32 v25, v125, v121, s80
  v_perm_b32 v29, v125, v121, s81
  v_perm_b32 v33, v126, v122, s80
  v_perm_b32 v37, v126, v122, s81
  v_perm_b32 v41, v127, v123, s80
  v_perm_b32 v45, v127, v123, s81
  s_waitcnt vmcnt(26)
  v_perm_b32 v18, v132, v128, s80
  v_perm_b32 v22, v132, v128, s81
  v_perm_b32 v26, v133, v129, s80
  v_perm_b32 v30, v133, v129, s81
  v_perm_b32 v34, v134, v130, s80
  v_perm_b32 v38, v134, v130, s81
  v_perm_b32 v42, v135, v131, s80
  v_perm_b32 v46, v135, v131, s81
  s_waitcnt vmcnt(24)
  v_perm_b32 v19, v140, v136, s80
  v_perm_b32 v23, v140, v136, s81
  v_perm_b32 v27, v141, v137, s80
  v_perm_b32 v31, v141, v137, s81
  v_perm_b32 v35, v142, v138, s80
  v_perm_b32 v39, v142, v138, s81
  v_perm_b32 v43, v143, v139, s80
  v_perm_b32 v47, v143, v139, s81
  v_mfma_f32_16x16x32_bf16 v[48:51], v[16:19], v[180:183], v[48:51]
  v_mfma_f32_16x16x32_bf16 v[52:55], v[20:23], v[180:183], v[52:55]
  v_mfma_f32_16x16x32_bf16 v[56:59], v[24:27], v[180:183], v[56:59]
  v_mfma_f32_16x16x32_bf16 v[60:63], v[28:31], v[180:183], v[60:63]
  v_mfma_f32_16x16x32_bf16 v[64:67], v[32:35], v[180:183], v[64:67]
  v_mfma_f32_16x16x32_bf16 v[68:71], v[36:39], v[180:183], v[68:71]
  v_mfma_f32_16x16x32_bf16 v[72:75], v[40:43], v[180:183], v[72:75]
  v_mfma_f32_16x16x32_bf16 v[76:79], v[44:47], v[180:183], v[76:79]
  s_mov_b32 exec_lo, 0x000f000f
  s_mov_b32 exec_hi, 0x000f000f
  ds_write_b128 v11, v[48:51] offset:10112
  ds_write_b128 v11, v[52:55] offset:10176
  ds_write_b128 v11, v[56:59] offset:10240
  ds_write_b128 v11, v[60:63] offset:10304
  ds_write_b128 v11, v[64:67] offset:10368
  ds_write_b128 v11, v[68:71] offset:10432
  ds_write_b128 v11, v[72:75] offset:10496
  ds_write_b128 v11, v[76:79] offset:10560
  s_mov_b64 exec, -1
L_pvdone:
L_bar1:
  s_waitcnt lgkmcnt(0)
  s_barrier
  s_cmp_ge_u32 s78, 2
  s_cbranch_scc1 L_fin
  ds_read_b128 v[16:19], v156 offset:10112
  ds_read_b128 v[20:23], v156 offset:12416
  ds_read_b128 v[24:27], v156 offset:14720
  ds_read_b128 v[28:31], v156 offset:17024
  ds_read_b128 v[32:35], v156 offset:19328
  ds_read_b128 v[36:39], v156 offset:21632
  ds_read_b128 v[40:43], v156 offset:23936
  ds_read_b128 v[44:47], v156 offset:26240
  s_waitcnt lgkmcnt(7)
  v_mul_f32 v68, v144, v16
  v_mul_f32 v69, v144, v17
  v_mul_f32 v70, v144, v18
  v_mul_f32 v71, v144, v19
  s_waitcnt lgkmcnt(6)
  v_fmac_f32 v68, v145, v20
  v_fmac_f32 v69, v145, v21
  v_fmac_f32 v70, v145, v22
  v_fmac_f32 v71, v145, v23
  s_waitcnt lgkmcnt(5)
  v_fmac_f32 v68, v146, v24
  v_fmac_f32 v69, v146, v25
  v_fmac_f32 v70, v146, v26
  v_fmac_f32 v71, v146, v27
  s_waitcnt lgkmcnt(4)
  v_fmac_f32 v68, v147, v28
  v_fmac_f32 v69, v147, v29
  v_fmac_f32 v70, v147, v30
  v_fmac_f32 v71, v147, v31
  s_waitcnt lgkmcnt(3)
  v_fmac_f32 v68, v148, v32
  v_fmac_f32 v69, v148, v33
  v_fmac_f32 v70, v148, v34
  v_fmac_f32 v71, v148, v35
  s_waitcnt lgkmcnt(2)
  v_fmac_f32 v68, v149, v36
  v_fmac_f32 v69, v149, v37
  v_fmac_f32 v70, v149, v38
  v_fmac_f32 v71, v149, v39
  s_waitcnt lgkmcnt(1)
  v_fmac_f32 v68, v150, v40
  v_fmac_f32 v69, v150, v41
  v_fmac_f32 v70, v150, v42
  v_fmac_f32 v71, v150, v43
  s_waitcnt lgkmcnt(0)
  v_fmac_f32 v68, v151, v44
  v_fmac_f32 v69, v151, v45
  v_fmac_f32 v70, v151, v46
  v_fmac_f32 v71, v151, v47
  v_bfi_b32 v68, v8, s68, v68
  v_bfi_b32 v69, v8, s69, v69
  v_bfi_b32 v70, v8, s70, v70
  v_bfi_b32 v71, v8, s71, v71
  s_cmp_eq_u32 s79, 1
  s_cbranch_scc1 L_pub_local
  buffer_store_dwordx4 v[68:71], v157, s[48:51], 0 offen sc1
  s_mov_b64 exec, s[90:91]
  buffer_store_dwordx4 v[152:155], v158, s[48:51], 0 offen sc1
  s_branch L_pub_done
L_pub_local:
  buffer_store_dwordx4 v[68:71], v157, s[48:51], 0 offen
  s_mov_b64 exec, s[90:91]
  buffer_store_dwordx4 v[152:155], v158, s[48:51], 0 offen
L_pub_done:
  s_mov_b64 exec, -1
  buffer_load_dwordx4 v[16:19], v160, s[48:51], 0 offen sc1
  buffer_load_dwordx4 v[20:23], v159, s[48:51], 0 offen offset:0 sc1
  buffer_load_dwordx4 v[24:27], v159, s[48:51], 0 offen offset:256 sc1
  buffer_load_dwordx4 v[28:31], v159, s[48:51], 0 offen offset:512 sc1
  buffer_load_dwordx4 v[32:35], v159, s[48:51], 0 offen offset:768 sc1
  buffer_load_dwordx4 v[36:39], v160, s[48:51], 0 offen sc1
  buffer_load_dwordx4 v[40:43], v159, s[48:51], 0 offen offset:0 sc1
  buffer_load_dwordx4 v[44:47], v159, s[48:51], 0 offen offset:256 sc1
  buffer_load_dwordx4 v[48:51], v159, s[48:51], 0 offen offset:512 sc1
  buffer_load_dwordx4 v[52:55], v159, s[48:51], 0 offen offset:768 sc1
  s_waitcnt vmcnt(10)
  s_mov_b32 s80, 0x05040100
  s_mov_b32 s81, 0x07060302
  s_mov_b32 s12, 0x00f000f0
  s_mov_b32 s13, 0x00f000f0
  s_mov_b32 s14, 0x0f000f00
  s_mov_b32 s15, 0x0f000f00
  s_mov_b32 s26, 0xf000f000
  s_mov_b32 s27, 0xf000f000
  v_perm_b32 v80, v186, v184, s80
  v_perm_b32 v84, v186, v184, s81
  v_perm_b32 v88, v187, v185, s80
  v_perm_b32 v92, v187, v185, s81
  v_perm_b32 v81, v190, v188, s80
  v_perm_b32 v85, v190, v188, s81
  v_perm_b32 v89, v191, v189, s80
  v_perm_b32 v93, v191, v189, s81
  v_perm_b32 v82, v194, v192, s80
  v_perm_b32 v86, v194, v192, s81
  v_perm_b32 v90, v195, v193, s80
  v_perm_b32 v94, v195, v193, s81
  v_perm_b32 v83, v198, v196, s80
  v_perm_b32 v87, v198, v196, s81
  v_perm_b32 v91, v199, v197, s80
  v_perm_b32 v95, v199, v197, s81
  v_perm_b32 v96, v202, v200, s80
  v_perm_b32 v100, v202, v200, s81
  v_perm_b32 v104, v203, v201, s80
  v_perm_b32 v108, v203, v201, s81
  v_perm_b32 v97, v206, v204, s80
  v_perm_b32 v101, v206, v204, s81
  v_perm_b32 v105, v207, v205, s80
  v_perm_b32 v109, v207, v205, s81
  v_perm_b32 v98, v210, v208, s80
  v_perm_b32 v102, v210, v208, s81
  v_perm_b32 v106, v211, v209, s80
  v_perm_b32 v110, v211, v209, s81
  v_perm_b32 v99, v214, v212, s80
  v_perm_b32 v103, v214, v212, s81
  v_perm_b32 v107, v215, v213, s80
  v_perm_b32 v111, v215, v213, s81
  v_perm_b32 v112, v218, v216, s80
  v_perm_b32 v116, v218, v216, s81
  v_perm_b32 v120, v219, v217, s80
  v_perm_b32 v124, v219, v217, s81
  v_perm_b32 v113, v222, v220, s80
  v_perm_b32 v117, v222, v220, s81
  v_perm_b32 v121, v223, v221, s80
  v_perm_b32 v125, v223, v221, s81
  v_perm_b32 v114, v226, v224, s80
  v_perm_b32 v118, v226, v224, s81
  v_perm_b32 v122, v227, v225, s80
  v_perm_b32 v126, v227, v225, s81
  v_perm_b32 v115, v230, v228, s80
  v_perm_b32 v119, v230, v228, s81
  v_perm_b32 v123, v231, v229, s80
  v_perm_b32 v127, v231, v229, s81
  s_lshl_b32 s4, s2, 11
  s_lshl_b32 s5, s78, 10
  s_add_u32 s4, s4, s5
  s_add_u32 s4, s4, 2162688
  v_lshlrev_b32 v12, 6, v3
  v_lshl_add_u32 v12, v2, 4, v12
  v_add_u32 v12, s4, v12
  v_and_b32 v9, 3, v3
  v_mul_u32_u24 v10, 144, v9
  v_lshl_add_u32 v10, v2, 4, v10
  v_mul_u32_u24 v11, 80, v9
  v_lshl_add_u32 v11, v2, 4, v11
  ds_read_b128 v[240:243], v11 offset:29376
  v_lshrrev_b32 v14, 1, v2
  s_lshl_b32 s4, s78, 1
  v_add_u32 v14, s4, v14
  v_mul_u32_u24 v14, 144, v14
  v_lshl_add_u32 v14, v3, 3, v14
  s_waitcnt lgkmcnt(0)
  v_mfma_f32_16x16x32_bf16 v[128:131], v[112:115], v[240:243], 0
  v_mfma_f32_16x16x32_bf16 v[132:135], v[116:119], v[240:243], 0
  v_mfma_f32_16x16x32_bf16 v[136:139], v[120:123], v[240:243], 0
  v_mfma_f32_16x16x32_bf16 v[140:143], v[124:127], v[240:243], 0
  s_mov_b32 s83, 0
L_ofull_36:
  s_waitcnt vmcnt(5)
  v_xor_b32 v16, s68, v16
  v_xor_b32 v17, s69, v17
  v_xor_b32 v18, s70, v18
  v_xor_b32 v19, s71, v19
  v_xor_b32 v20, s68, v20
  v_xor_b32 v21, s69, v21
  v_xor_b32 v22, s70, v22
  v_xor_b32 v23, s71, v23
  v_xor_b32 v24, s68, v24
  v_xor_b32 v25, s69, v25
  v_xor_b32 v26, s70, v26
  v_xor_b32 v27, s71, v27
  v_xor_b32 v28, s68, v28
  v_xor_b32 v29, s69, v29
  v_xor_b32 v30, s70, v30
  v_xor_b32 v31, s71, v31
  v_xor_b32 v32, s68, v32
  v_xor_b32 v33, s69, v33
  v_xor_b32 v34, s70, v34
  v_xor_b32 v35, s71, v35
  v_or3_b32 v15, v16, v17, v18
  v_or3_b32 v15, v15, v19, v20
  v_or3_b32 v15, v15, v21, v22
  v_or3_b32 v15, v15, v23, v24
  v_or3_b32 v15, v15, v25, v26
  v_or3_b32 v15, v15, v27, v28
  v_or3_b32 v15, v15, v29, v30
  v_or3_b32 v15, v15, v31, v32
  v_or3_b32 v15, v15, v33, v34
  v_or_b32 v15, v15, v35
  v_and_b32 v15, v8, v15
  v_cmp_ne_u32 vcc, 0, v15
  s_cbranch_vccz L_ook_37
  buffer_load_dwordx4 v[16:19], v160, s[48:51], 0 offen sc1
  buffer_load_dwordx4 v[20:23], v159, s[48:51], 0 offen offset:0 sc1
  buffer_load_dwordx4 v[24:27], v159, s[48:51], 0 offen offset:256 sc1
  buffer_load_dwordx4 v[28:31], v159, s[48:51], 0 offen offset:512 sc1
  buffer_load_dwordx4 v[32:35], v159, s[48:51], 0 offen offset:768 sc1
  s_waitcnt vmcnt(5)
  v_xor_b32 v36, s68, v36
  v_xor_b32 v37, s69, v37
  v_xor_b32 v38, s70, v38
  v_xor_b32 v39, s71, v39
  v_xor_b32 v40, s68, v40
  v_xor_b32 v41, s69, v41
  v_xor_b32 v42, s70, v42
  v_xor_b32 v43, s71, v43
  v_xor_b32 v44, s68, v44
  v_xor_b32 v45, s69, v45
  v_xor_b32 v46, s70, v46
  v_xor_b32 v47, s71, v47
  v_xor_b32 v48, s68, v48
  v_xor_b32 v49, s69, v49
  v_xor_b32 v50, s70, v50
  v_xor_b32 v51, s71, v51
  v_xor_b32 v52, s68, v52
  v_xor_b32 v53, s69, v53
  v_xor_b32 v54, s70, v54
  v_xor_b32 v55, s71, v55
  v_or3_b32 v15, v36, v37, v38
  v_or3_b32 v15, v15, v39, v40
  v_or3_b32 v15, v15, v41, v42
  v_or3_b32 v15, v15, v43, v44
  v_or3_b32 v15, v15, v45, v46
  v_or3_b32 v15, v15, v47, v48
  v_or3_b32 v15, v15, v49, v50
  v_or3_b32 v15, v15, v51, v52
  v_or3_b32 v15, v15, v53, v54
  v_or_b32 v15, v15, v55
  v_and_b32 v15, v8, v15
  v_cmp_ne_u32 vcc, 0, v15
  s_cbranch_vccz L_ook_38
  buffer_load_dwordx4 v[36:39], v160, s[48:51], 0 offen sc1
  buffer_load_dwordx4 v[40:43], v159, s[48:51], 0 offen offset:0 sc1
  buffer_load_dwordx4 v[44:47], v159, s[48:51], 0 offen offset:256 sc1
  buffer_load_dwordx4 v[48:51], v159, s[48:51], 0 offen offset:512 sc1
  buffer_load_dwordx4 v[52:55], v159, s[48:51], 0 offen offset:768 sc1
  s_add_u32 s83, s83, 1
  s_cmp_lt_u32 s83, 200000
  s_cbranch_scc1 L_ofull_36
  s_branch L_ook_37
L_ook_38:
  v_max_f32_dpp v60, v36, v36 row_ror:4 row_mask:0xf bank_mask:0xf
  s_nop 1
  v_max_f32_dpp v60, v60, v60 row_ror:2 row_mask:0xf bank_mask:0xf
  s_nop 1
  v_max_f32_dpp v60, v60, v60 row_ror:1 row_mask:0xf bank_mask:0xf
  v_sub_f32 v61, v36, v60
  v_exp_f32 v61, v61
  s_nop 0
  v_mul_f32 v62, v61, v37
  s_nop 1
  v_add_f32_dpp v62, v62, v62 row_ror:4 row_mask:0xf bank_mask:0xf
  s_nop 1
  v_add_f32_dpp v62, v62, v62 row_ror:2 row_mask:0xf bank_mask:0xf
  s_nop 1
  v_add_f32_dpp v62, v62, v62 row_ror:1 row_mask:0xf bank_mask:0xf
  v_rcp_f32 v62, v62
  s_nop 0
  v_mul_f32 v61, v61, v62
  s_nop 1
  v_mul_f32_dpp v56, v61, v40 row_newbcast:0 row_mask:0xf bank_mask:0xf
  v_mul_f32_dpp v57, v61, v41 row_newbcast:0 row_mask:0xf bank_mask:0xf
  v_mul_f32_dpp v58, v61, v42 row_newbcast:0 row_mask:0xf bank_mask:0xf
  v_mul_f32_dpp v59, v61, v43 row_newbcast:0 row_mask:0xf bank_mask:0xf
  v_fmac_f32_dpp v56, v61, v44 row_newbcast:1 row_mask:0xf bank_mask:0xf
  v_fmac_f32_dpp v57, v61, v45 row_newbcast:1 row_mask:0xf bank_mask:0xf
  v_fmac_f32_dpp v58, v61, v46 row_newbcast:1 row_mask:0xf bank_mask:0xf
  v_fmac_f32_dpp v59, v61, v47 row_newbcast:1 row_mask:0xf bank_mask:0xf
  v_fmac_f32_dpp v56, v61, v48 row_newbcast:2 row_mask:0xf bank_mask:0xf
  v_fmac_f32_dpp v57, v61, v49 row_newbcast:2 row_mask:0xf bank_mask:0xf
  v_fmac_f32_dpp v58, v61, v50 row_newbcast:2 row_mask:0xf bank_mask:0xf
  v_fmac_f32_dpp v59, v61, v51 row_newbcast:2 row_mask:0xf bank_mask:0xf
  v_fmac_f32_dpp v56, v61, v52 row_newbcast:3 row_mask:0xf bank_mask:0xf
  v_fmac_f32_dpp v57, v61, v53 row_newbcast:3 row_mask:0xf bank_mask:0xf
  v_fmac_f32_dpp v58, v61, v54 row_newbcast:3 row_mask:0xf bank_mask:0xf
  v_fmac_f32_dpp v59, v61, v55 row_newbcast:3 row_mask:0xf bank_mask:0xf
  s_branch L_ofin_39
L_ook_37:
  v_max_f32_dpp v60, v16, v16 row_ror:4 row_mask:0xf bank_mask:0xf
  s_nop 1
  v_max_f32_dpp v60, v60, v60 row_ror:2 row_mask:0xf bank_mask:0xf
  s_nop 1
  v_max_f32_dpp v60, v60, v60 row_ror:1 row_mask:0xf bank_mask:0xf
  v_sub_f32 v61, v16, v60
  v_exp_f32 v61, v61
  s_nop 0
  v_mul_f32 v62, v61, v17
  s_nop 1
  v_add_f32_dpp v62, v62, v62 row_ror:4 row_mask:0xf bank_mask:0xf
  s_nop 1
  v_add_f32_dpp v62, v62, v62 row_ror:2 row_mask:0xf bank_mask:0xf
  s_nop 1
  v_add_f32_dpp v62, v62, v62 row_ror:1 row_mask:0xf bank_mask:0xf
  v_rcp_f32 v62, v62
  s_nop 0
  v_mul_f32 v61, v61, v62
  s_nop 1
  v_mul_f32_dpp v56, v61, v20 row_newbcast:0 row_mask:0xf bank_mask:0xf
  v_mul_f32_dpp v57, v61, v21 row_newbcast:0 row_mask:0xf bank_mask:0xf
  v_mul_f32_dpp v58, v61, v22 row_newbcast:0 row_mask:0xf bank_mask:0xf
  v_mul_f32_dpp v59, v61, v23 row_newbcast:0 row_mask:0xf bank_mask:0xf
  v_fmac_f32_dpp v56, v61, v24 row_newbcast:1 row_mask:0xf bank_mask:0xf
  v_fmac_f32_dpp v57, v61, v25 row_newbcast:1 row_mask:0xf bank_mask:0xf
  v_fmac_f32_dpp v58, v61, v26 row_newbcast:1 row_mask:0xf bank_mask:0xf
  v_fmac_f32_dpp v59, v61, v27 row_newbcast:1 row_mask:0xf bank_mask:0xf
  v_fmac_f32_dpp v56, v61, v28 row_newbcast:2 row_mask:0xf bank_mask:0xf
  v_fmac_f32_dpp v57, v61, v29 row_newbcast:2 row_mask:0xf bank_mask:0xf
  v_fmac_f32_dpp v58, v61, v30 row_newbcast:2 row_mask:0xf bank_mask:0xf
  v_fmac_f32_dpp v59, v61, v31 row_newbcast:2 row_mask:0xf bank_mask:0xf
  v_fmac_f32_dpp v56, v61, v32 row_newbcast:3 row_mask:0xf bank_mask:0xf
  v_fmac_f32_dpp v57, v61, v33 row_newbcast:3 row_mask:0xf bank_mask:0xf
  v_fmac_f32_dpp v58, v61, v34 row_newbcast:3 row_mask:0xf bank_mask:0xf
  v_fmac_f32_dpp v59, v61, v35 row_newbcast:3 row_mask:0xf bank_mask:0xf
L_ofin_39:
  v_mov_b32 v64, v56
  v_mov_b32 v65, v57
  v_mov_b32 v66, v58
  v_mov_b32 v67, v59
  v_permlane16_swap_b32 v56, v64
  v_permlane16_swap_b32 v57, v65
  v_permlane16_swap_b32 v58, v66
  v_permlane16_swap_b32 v59, v67
  v_add_f32 v56, v56, v64
  v_add_f32 v57, v57, v65
  v_add_f32 v58, v58, v66
  v_add_f32 v59, v59, v67
  v_cvt_pk_bf16_f32 v56, v56, v57
  v_cvt_pk_bf16_f32 v57, v58, v59
  s_mov_b32 exec_lo, 0x0000ffff
  s_mov_b32 exec_hi, 0x0000ffff
  ds_write_b64 v14, v[56:57] offset:28800
  s_mov_b64 exec, -1
L_bar2:
  s_waitcnt lgkmcnt(0)
  s_barrier
  ds_read_b128 v[232:235], v10 offset:28800
  ds_read_b128 v[236:239], v10 offset:28864
  s_waitcnt lgkmcnt(0)
  v_mfma_f32_16x16x32_bf16 v[128:131], v[80:83], v[232:235], v[128:131]
  v_mfma_f32_16x16x32_bf16 v[132:135], v[84:87], v[232:235], v[132:135]
  v_mfma_f32_16x16x32_bf16 v[136:139], v[88:91], v[232:235], v[136:139]
  v_mfma_f32_16x16x32_bf16 v[140:143], v[92:95], v[232:235], v[140:143]
  v_mfma_f32_16x16x32_bf16 v[128:131], v[96:99], v[236:239], v[128:131]
  v_mfma_f32_16x16x32_bf16 v[132:135], v[100:103], v[236:239], v[132:135]
  v_mfma_f32_16x16x32_bf16 v[136:139], v[104:107], v[236:239], v[136:139]
  v_mfma_f32_16x16x32_bf16 v[140:143], v[108:111], v[236:239], v[140:143]
  s_lshr_b32 s4, s2, 5
  s_lshl_b32 s4, s4, 6
  s_and_b32 s5, s2, 3
  s_lshl_b32 s5, s5, 8
  s_add_u32 s4, s4, s5
  s_bfe_u32 s5, s2, 0x10002
  s_lshl_b32 s5, s5, 10
  s_add_u32 s4, s4, s5
  s_bfe_u32 s5, s2, 0x20003
  s_lshl_b32 s5, s5, 17
  s_add_u32 s4, s4, s5
  s_add_u32 s4, s4, 2162688
  v_cndmask_b32 v72, v128, v129, s[12:13]
  v_cndmask_b32 v73, v132, v133, s[12:13]
  v_cndmask_b32 v74, v136, v137, s[12:13]
  v_cndmask_b32 v75, v140, v141, s[12:13]
  v_cndmask_b32 v72, v72, v130, s[14:15]
  v_cndmask_b32 v73, v73, v134, s[14:15]
  v_cndmask_b32 v74, v74, v138, s[14:15]
  v_cndmask_b32 v75, v75, v142, s[14:15]
  v_cndmask_b32 v72, v72, v131, s[26:27]
  v_cndmask_b32 v73, v73, v135, s[26:27]
  v_cndmask_b32 v74, v74, v139, s[26:27]
  v_cndmask_b32 v75, v75, v143, s[26:27]
  v_bfi_b32 v72, v8, s68, v72
  v_bfi_b32 v73, v8, s69, v73
  v_bfi_b32 v74, v8, s70, v74
  v_bfi_b32 v75, v8, s71, v75
  buffer_store_dwordx4 v[72:75], v12, s[48:51], 0 offen sc1
  s_cmp_eq_u32 s78, 1
  s_cbranch_scc0 L_fin
  s_cmp_lt_u32 s2, 128
  s_cbranch_scc0 L_fin
  v_lshrrev_b32 v9, 2, v1
  v_lshlrev_b32 v9, 13, v9
  v_and_b32 v10, 3, v1
  v_lshl_add_u32 v9, v10, 4, v9
  v_add_u32 v9, s4, v9
  s_mov_b32 s64, s34
  s_mov_b32 s65, s35
  s_mov_b32 s66, 4096
  s_mov_b32 s67, 0x20000
  s_lshr_b32 s5, s2, 5
  s_lshl_b32 s5, s5, 9
  s_bfe_u32 s6, s2, 0x20003
  s_lshl_b32 s6, s6, 7
  s_add_u32 s5, s5, s6
  s_and_b32 s6, s2, 3
  s_lshl_b32 s6, s6, 2
  s_add_u32 s5, s5, s6
  s_bfe_u32 s6, s2, 0x10002
  s_lshl_b32 s6, s6, 6
  s_add_u32 s5, s5, s6
  v_lshl_add_u32 v11, v10, 4, v2
  v_add_u32 v11, s5, v11
  v_lshlrev_b32 v11, 1, v11
  buffer_load_ushort v12, v11, s[60:63], 0 offen
  s_mov_b32 s83, 0
  buffer_load_dwordx4 v[16:19], v9, s[48:51], 0 offen offset:0 sc1
  buffer_load_dwordx4 v[20:23], v9, s[48:51], 0 offen offset:2048 sc1
  buffer_load_dwordx4 v[24:27], v9, s[48:51], s9 offen offset:0 sc1
  buffer_load_dwordx4 v[28:31], v9, s[48:51], s9 offen offset:2048 sc1
  buffer_load_dwordx4 v[64:67], v9, s[48:51], 0 offen offset:0 sc1
  buffer_load_dwordx4 v[68:71], v9, s[48:51], 0 offen offset:2048 sc1
  buffer_load_dwordx4 v[72:75], v9, s[48:51], s9 offen offset:0 sc1
  buffer_load_dwordx4 v[76:79], v9, s[48:51], s9 offen offset:2048 sc1
L_ffull_40:
  s_waitcnt vmcnt(4)
  v_xor_b32 v16, s68, v16
  v_xor_b32 v17, s69, v17
  v_xor_b32 v18, s70, v18
  v_xor_b32 v19, s71, v19
  v_xor_b32 v20, s68, v20
  v_xor_b32 v21, s69, v21
  v_xor_b32 v22, s70, v22
  v_xor_b32 v23, s71, v23
  v_xor_b32 v24, s68, v24
  v_xor_b32 v25, s69, v25
  v_xor_b32 v26, s70, v26
  v_xor_b32 v27, s71, v27
  v_xor_b32 v28, s68, v28
  v_xor_b32 v29, s69, v29
  v_xor_b32 v30, s70, v30
  v_xor_b32 v31, s71, v31
  v_or3_b32 v13, v16, v17, v18
  v_or3_b32 v13, v13, v19, v20
  v_or3_b32 v13, v13, v21, v22
  v_or3_b32 v13, v13, v23, v24
  v_or3_b32 v13, v13, v25, v26
  v_or3_b32 v13, v13, v27, v28
  v_or3_b32 v13, v13, v29, v30
  v_or_b32 v13, v13, v31
  v_and_b32 v13, v8, v13
  v_cmp_ne_u32 vcc, 0, v13
  s_cbranch_vccz L_fd_41
  buffer_load_dwordx4 v[16:19], v9, s[48:51], 0 offen offset:0 sc1
  buffer_load_dwordx4 v[20:23], v9, s[48:51], 0 offen offset:2048 sc1
  buffer_load_dwordx4 v[24:27], v9, s[48:51], s9 offen offset:0 sc1
  buffer_load_dwordx4 v[28:31], v9, s[48:51], s9 offen offset:2048 sc1
  s_waitcnt vmcnt(4)
  v_xor_b32 v64, s68, v64
  v_xor_b32 v65, s69, v65
  v_xor_b32 v66, s70, v66
  v_xor_b32 v67, s71, v67
  v_xor_b32 v68, s68, v68
  v_xor_b32 v69, s69, v69
  v_xor_b32 v70, s70, v70
  v_xor_b32 v71, s71, v71
  v_xor_b32 v72, s68, v72
  v_xor_b32 v73, s69, v73
  v_xor_b32 v74, s70, v74
  v_xor_b32 v75, s71, v75
  v_xor_b32 v76, s68, v76
  v_xor_b32 v77, s69, v77
  v_xor_b32 v78, s70, v78
  v_xor_b32 v79, s71, v79
  v_or3_b32 v13, v64, v65, v66
  v_or3_b32 v13, v13, v67, v68
  v_or3_b32 v13, v13, v69, v70
  v_or3_b32 v13, v13, v71, v72
  v_or3_b32 v13, v13, v73, v74
  v_or3_b32 v13, v13, v75, v76
  v_or3_b32 v13, v13, v77, v78
  v_or_b32 v13, v13, v79
  v_and_b32 v13, v8, v13
  v_cmp_ne_u32 vcc, 0, v13
  s_cbranch_vccz L_fd_42
  buffer_load_dwordx4 v[64:67], v9, s[48:51], 0 offen offset:0 sc1
  buffer_load_dwordx4 v[68:71], v9, s[48:51], 0 offen offset:2048 sc1
  buffer_load_dwordx4 v[72:75], v9, s[48:51], s9 offen offset:0 sc1
  buffer_load_dwordx4 v[76:79], v9, s[48:51], s9 offen offset:2048 sc1
  s_add_u32 s83, s83, 1
  s_cmp_lt_u32 s83, 200000
  s_cbranch_scc1 L_ffull_40
  s_branch L_fd_41
L_fd_42:
  v_add_f32 v144, v64, v68
  v_add_f32 v148, v72, v76
  v_add_f32 v145, v65, v69
  v_add_f32 v149, v73, v77
  v_add_f32 v146, v66, v70
  v_add_f32 v150, v74, v78
  v_add_f32 v147, v67, v71
  v_add_f32 v151, v75, v79
  s_branch L_ffin_43
L_fd_41:
  v_add_f32 v144, v16, v20
  v_add_f32 v148, v24, v28
  v_add_f32 v145, v17, v21
  v_add_f32 v149, v25, v29
  v_add_f32 v146, v18, v22
  v_add_f32 v150, v26, v30
  v_add_f32 v147, v19, v23
  v_add_f32 v151, v27, v31
L_ffin_43:
  v_add_f32 v144, v144, v148
  v_add_f32 v145, v145, v149
  v_add_f32 v146, v146, v150
  v_add_f32 v147, v147, v151
  v_add_f32_dpp v144, v144, v144 row_ror:8 row_mask:0xf bank_mask:0xf
  v_add_f32_dpp v145, v145, v145 row_ror:8 row_mask:0xf bank_mask:0xf
  v_add_f32_dpp v146, v146, v146 row_ror:8 row_mask:0xf bank_mask:0xf
  v_add_f32_dpp v147, v147, v147 row_ror:8 row_mask:0xf bank_mask:0xf
  v_add_f32_dpp v144, v144, v144 row_ror:4 row_mask:0xf bank_mask:0xf
  v_add_f32_dpp v145, v145, v145 row_ror:4 row_mask:0xf bank_mask:0xf
  v_add_f32_dpp v146, v146, v146 row_ror:4 row_mask:0xf bank_mask:0xf
  v_add_f32_dpp v147, v147, v147 row_ror:4 row_mask:0xf bank_mask:0xf
  v_permlane16_swap_b32 v144, v145
  s_nop 0
  v_permlane16_swap_b32 v146, v147
  v_add_f32 v144, v144, v145
  v_add_f32 v146, v146, v147
  s_nop 1
  v_permlane32_swap_b32 v144, v146
  v_add_f32 v144, v144, v146
  v_lshlrev_b32 v12, 16, v12
  v_add_f32 v144, v144, v12
  v_cvt_pk_bf16_f32 v144, v144, v144
  s_mov_b32 exec_lo, 0x000f000f
  s_mov_b32 exec_hi, 0x000f000f
  buffer_store_short v144, v11, s[64:67], 0 offen
  s_mov_b64 exec, -1
  s_cmp_eq_u32 s2, 0
  s_cbranch_scc0 L_fin
  v_mov_b32 v160, s72
  v_mov_b32 v161, s73
  v_mov_b32 v162, 0
  s_mov_b64 exec, 1
  buffer_store_dwordx2 v[160:161], v162, s[48:51], 0 offen
  s_mov_b64 exec, -1
L_fin:
L_end:
  s_endpgm
.section .rodata,"a"
.p2align 6
.amdhsa_kernel parallel_sum__gqa_block_cached__glu_gated_geglu__decode_kernel
  .amdhsa_next_free_vgpr 256
  .amdhsa_next_free_sgpr 102
  .amdhsa_accum_offset 256
  .amdhsa_group_segment_fixed_size 0
  .amdhsa_kernarg_size 96
  .amdhsa_user_sgpr_count 2
  .amdhsa_user_sgpr_kernarg_segment_ptr 1
  .amdhsa_system_sgpr_workgroup_id_x 1
.end_amdhsa_kernel
```
